```python
import torch

def _softmax(x, axis=-1):
    return torch.softmax(x, dim=axis)
def _gelu(x):
    return torch.nn.functional.gelu(x, approximate="tanh")
def _silu(x):
    return torch.nn.functional.silu(x)
def _sigmoid(x):
    return torch.sigmoid(x)
def _layernorm(x, axis=-1, eps=1e-5):
    m = x.mean(dim=axis, keepdim=True)
    v = x.var(dim=axis, keepdim=True, unbiased=False)
    return (x - m) / torch.sqrt(v + eps)
def _scatter_add(tgt, idx, src, axis=0):
    return tgt.clone().index_add_(axis, idx, src)
def _segment_sum(src, seg, n):
    out = torch.zeros((n,) + src.shape[1:], dtype=src.dtype)
    return out.index_add_(0, seg, src)
def _pad(x, pw):
    flat = tuple(v for pair in reversed(pw) for v in pair)
    return torch.nn.functional.pad(x, flat)

kernel_name = 'recurrent_scan__sliding_block_cached__moe_arch_mod__prompt'

def setup_inputs():

    _w = (lambda a: (lambda t: t.to(torch.bfloat16) if t.is_floating_point() else t)(torch.as_tensor(a)))
    def _A_setup():
        B, Sq, D = 1, 2048, 512
        Hq, Hkv, Sk, Dh = 32, 32, 2048, 128
        assert Hq % Hkv == 0, (Hq, Hkv)
        return {
            "x": _w((lambda *s: torch.randn(*s, dtype=torch.bfloat16) * 0.05)(B, Sq, D)),
            "k_cache": _w((lambda *s: torch.randn(*s, dtype=torch.bfloat16) * 0.8)(B, Hkv, Sk, Dh)),
            "v_cache": _w((lambda *s: torch.randn(*s, dtype=torch.bfloat16) * 0.2)(B, Hkv, Sk, Dh)),
            "wq": _w((lambda *s: torch.randn(*s, dtype=torch.bfloat16) * 0.8)(D, Hq * Dh) * (D ** -0.5)),
            "wo": _w((lambda *s: torch.randn(*s, dtype=torch.bfloat16) * 0.2)(Hq * Dh, D) * ((Hq * Dh) ** -0.5)),
        }
    _A_in = _A_setup()

    def _B_setup():
        B, S, D, F, C = 1, 2048, 512, 1376, 1
        return {
            "x": _w((lambda *s: torch.randn(*s, dtype=torch.bfloat16) * 0.05)(B, S, D)),
            "w_r": _w((lambda *s: torch.randn(*s, dtype=torch.bfloat16) * 0.2)(D)),
            "w_gate": _w((lambda *s: torch.randn(*s, dtype=torch.bfloat16) * 0.1)(D, F)),
            "w_up": _w((lambda *s: torch.randn(*s, dtype=torch.bfloat16) * 0.1)(D, F)),
            "w_down": _w((lambda *s: torch.randn(*s, dtype=torch.bfloat16) * 0.1)(F, D)),
        }
    _B_in = _B_setup()

    return {
        "A_x": _A_in["x"],
        "A_k_cache": _A_in["k_cache"],
        "A_v_cache": _A_in["v_cache"],
        "A_wq": _A_in["wq"],
        "A_wo": _A_in["wo"],
        "B_x": _B_in["x"],
        "B_w_r": _B_in["w_r"],
        "B_w_gate": _B_in["w_gate"],
        "B_w_up": _B_in["w_up"],
        "B_w_down": _B_in["w_down"],
    }

def reference(A_x, A_k_cache, A_v_cache, A_wq, A_wo, B_x, B_w_r, B_w_gate, B_w_up, B_w_down):
    def _A_ref(x, k_cache, v_cache, wq, wo):
        B, Sq, D = x.shape
        Hq, Dh = 32, 128
        Hkv, Sk = k_cache.shape[1], k_cache.shape[2]
        W = min(4096, max(256, Sk // 4))
        rep = Hq // Hkv
        q = (lambda x, *d: x.permute(*d))((x @ wq).reshape(B, Sq, Hq, Dh), 0, 2, 1, 3)
        k = (lambda x, n, axis: torch.repeat_interleave(x, n, dim=axis))(k_cache[:, :, Sk - W:, :], rep, axis=1)
        v = (lambda x, n, axis: torch.repeat_interleave(x, n, dim=axis))(v_cache[:, :, Sk - W:, :], rep, axis=1)
        scores = torch.einsum("bhqd,bhkd->bhqk", q, k) * (Dh ** -0.5)
        p = _softmax(scores, axis=-1)
        o = torch.einsum("bhqk,bhkd->bhqd", p, v)
        return (lambda x, *d: x.permute(*d))(o, 0, 2, 1, 3).reshape(B, Sq, Hq * Dh) @ wo

    def _B_ref(x, w_r, w_gate, w_up, w_down):
        B, S, D = x.shape
        C = 1
        r = x @ w_r
        idx = torch.argsort(-r, axis=-1)[:, :C]
        idx_e = (lambda x, n, axis: torch.repeat_interleave(x, n, dim=axis))(idx.reshape(B, C, 1), D, axis=2)
        x_sel = (lambda x, i, axis: torch.take_along_dim(x, i, dim=axis))(x, idx_e, axis=1)
        g = _silu(x_sel @ w_gate)
        u = x_sel @ w_up
        y = (g * u) @ w_down
        r_sel = _sigmoid((lambda x, i, axis: torch.take_along_dim(x, i, dim=axis))(r, idx, axis=1))
        y = y * r_sel.reshape(B, C, 1)
        b_off = (torch.arange(B) * S).reshape(B, 1)
        flat_idx = (idx + b_off).reshape(B * C)
        zero = (x * 0.0).reshape(B * S, D)
        upd = _scatter_add(zero, flat_idx, y.reshape(B * C, D), axis=0)
        return x + upd.reshape(B, S, D)

    x = A_x
    xn = _layernorm(x, axis=-1)
    s = _A_ref(xn, A_k_cache, A_v_cache, A_wq, A_wo)
    g = _silu(_B_ref(xn, B_w_r, B_w_gate, B_w_up, B_w_down))
    return x + s * g
```

```asm
; @launch grid=(256,1,1) block=(512,1,1) lds=163840
.amdgcn_target "amdgcn-amd-amdhsa--gfx950"
.text
.globl recurrent_scan__sliding_block_cached__moe_arch_mod__prompt_kernel
.p2align 8
.type recurrent_scan__sliding_block_cached__moe_arch_mod__prompt_kernel,@function
recurrent_scan__sliding_block_cached__moe_arch_mod__prompt_kernel:
  s_cmp_ge_u32 s2, 256
  s_cbranch_scc1 L_end
  s_load_dwordx2 s[4:5], s[0:1], 0
  s_load_dwordx2 s[8:9], s[0:1], 24
  s_load_dwordx2 s[36:37], s[0:1], 48
  s_load_dwordx2 s[24:25], s[0:1], 96
  s_load_dwordx2 s[12:13], s[0:1], 8
  s_load_dwordx2 s[16:17], s[0:1], 16
  s_load_dwordx2 s[28:29], s[0:1], 88
  s_load_dwordx2 s[20:21], s[0:1], 32
  s_load_dwordx2 s[40:41], s[0:1], 56
  s_load_dwordx2 s[44:45], s[0:1], 64
  s_load_dwordx2 s[48:49], s[0:1], 72
  s_load_dwordx2 s[32:33], s[0:1], 80
  v_lshrrev_b32 v2, 6, v0
  v_and_b32 v255, 63, v0
  v_mov_b32 v64, v0
  s_lshr_b32 s53, s2, 5
  s_and_b32 s54, s2, 7
  s_lshl_b32 s54, s54, 2
  s_bfe_u32 s64, s2, 0x20003
  s_add_u32 s54, s54, s64
  v_readfirstlane_b32 s52, v2
  s_mov_b32 s6, 2097152
  s_mov_b32 s7, 0x20000
  s_mov_b32 s10, 4194304
  s_mov_b32 s11, 0x20000
  s_mov_b32 s38, 1024
  s_mov_b32 s39, 0x20000
  v_lshrrev_b32 v0, 3, v255
  v_and_b32 v1, 7, v255
  v_lshrrev_b32 v2, 4, v255
  v_xor_b32 v3, v1, v2
  v_lshlrev_b32 v3, 4, v3
  v_lshl_add_u32 v65, v0, 10, v3
  v_xor_b32 v66, 64, v65
  v_add_u32 v66, 7168, v66
  v_add_u32 v67, 14336, v65
  v_add_u32 v68, 14336, v66
  v_and_b32 v4, 15, v255
  v_lshlrev_b32 v5, 2, v2
  v_xor_b32 v5, v4, v5
  v_lshlrev_b32 v5, 4, v5
  v_lshl_add_u32 v69, v2, 13, v5
  v_add_u32 v70, 31744, v69
  v_lshlrev_b32 v7, 4, v255
  s_lshl_b32 s55, s52, 12
  s_lshl_b32 s57, s53, 18
  s_lshl_b32 s65, s52, 15
  s_add_u32 s57, s57, s65
  s_lshl_b32 s58, s52, 16
  s_lshl_b32 s65, s54, 8
  s_add_u32 s58, s58, s65
  s_and_b32 s65, s53, 3
  s_lshl_b32 s66, s65, 7
  s_or_b32 s57, s57, s66
  s_lshl_b32 s66, s65, 19
  s_or_b32 s58, s58, s66
  s_lshl_b32 s66, s53, 8
  s_lshl_b32 s65, s54, 3
  s_add_u32 s66, s66, s65
  s_add_u32 s66, s66, s52
  s_lshl_b32 s67, s66, 10
  s_waitcnt lgkmcnt(0)
  buffer_load_dwordx4 v[216:219], v7, s[4:7], s67 offen
  buffer_load_dwordx4 v[220:223], v7, s[36:39], 0 offen
  s_add_u32 m0, s55, 98304
  s_xor_b32 s64, s58, 0
  buffer_load_dwordx4 v69, s[8:11], s64 offen offset:0 lds
  s_add_u32 m0, s55, 98304
  s_xor_b32 s64, s58, 0
  buffer_load_dwordx4 v70, s[8:11], s64 offen offset:1024 lds
  s_cmp_ge_u32 s52, 4
  s_cbranch_scc1 L_x0a
  s_add_u32 m0, s55, 32768
  s_xor_b32 s64, s57, 0
  buffer_load_dwordx4 v65, s[4:7], s64 offen offset:0 lds
  s_add_u32 m0, s55, 32768
  s_xor_b32 s64, s57, 0
  buffer_load_dwordx4 v66, s[4:7], s64 offen offset:1024 lds
  s_add_u32 m0, s55, 32768
  s_xor_b32 s64, s57, 0
  buffer_load_dwordx4 v67, s[4:7], s64 offen offset:2048 lds
  s_add_u32 m0, s55, 32768
  s_xor_b32 s64, s57, 0
  buffer_load_dwordx4 v68, s[4:7], s64 offen offset:3072 lds
L_x0a:
  s_mov_b32 s26, 27262976
  s_mov_b32 s27, 0x20000
  s_mov_b32 s14, 16777216
  s_mov_b32 s15, 0x20000
  s_mov_b32 s18, 16777216
  s_mov_b32 s19, 0x20000
  s_mov_b32 s30, 256
  s_mov_b32 s31, 0x20000
  s_mov_b32 s22, 4194304
  s_mov_b32 s23, 0x20000
  s_mov_b32 s42, 1409024
  s_mov_b32 s43, 0x20000
  s_mov_b32 s46, 1409024
  s_mov_b32 s47, 0x20000
  s_mov_b32 s50, 1409024
  s_mov_b32 s51, 0x20000
  s_mov_b32 s34, 2097152
  s_mov_b32 s35, 0x20000
  s_lshl_b32 s56, s53, 5
  s_add_u32 s56, s56, s54
  s_lshl_b32 s74, s53, 5
  s_lshr_b32 s69, s52, 1
  s_lshl_b32 s69, s69, 3
  s_add_u32 s74, s74, s69
  s_lshr_b32 s69, s54, 2
  s_add_u32 s74, s74, s69
  s_lshl_b32 s74, s74, 7
  s_add_u32 s98, s24, 16809984
  s_addc_u32 s99, s25, 0
  v_mov_b32 v91, 0
  s_or_b32 s65, s2, s52
  s_cmp_lg_u32 s65, 0
  s_cbranch_scc1 L_non0
  s_mov_b32 s83, 1
  s_atomic_add s83, s[98:99], 65472 glc
L_non0:
  v_and_b32 v8, 31, v255
  v_lshrrev_b32 v9, 5, v255
  v_bfe_u32 v10, v255, 2, 2
  v_bfe_u32 v11, v255, 4, 1
  v_and_b32 v12, 3, v255
  v_add_u32 v88, -1, v9
  v_bfe_u32 v5, v255, 1, 3
  v_xor_b32 v5, v5, v9
  v_lshlrev_b32 v5, 4, v5
  v_lshl_add_u32 v5, v8, 7, v5
  s_add_u32 s65, s55, 32768
  v_add_u32 v71, s65, v5
  v_xor_b32 v72, 32, v71
  v_xor_b32 v73, 64, v71
  v_xor_b32 v74, 96, v71
  v_lshlrev_b32 v5, 1, v12
  v_and_b32 v5, 2, v5
  v_lshrrev_b32 v13, 1, v12
  v_or_b32 v13, v5, v13
  v_mul_u32_u24 v6, 320, v10
  v_lshl_add_u32 v6, v11, 5, v6
  v_lshl_add_u32 v5, v13, 3, v6
  v_lshl_add_u32 v75, v9, 12, v5
  v_xor_b32 v76, 64, v75
  v_xor_b32 v77, 128, v75
  v_xor_b32 v78, 192, v75
  v_add_u32 v224, 98304, v75
  v_add_u32 v225, 98304, v76
  v_add_u32 v226, 98304, v77
  v_add_u32 v227, 98304, v78
  v_lshl_add_u32 v6, v12, 3, v6
  v_lshlrev_b32 v5, 6, v9
  v_xor_b32 v5, v5, v6
  v_add_u32 v83, s55, v5
  v_xor_b32 v84, 128, v83
  v_add_u32 v85, 98304, v83
  v_add_u32 v86, 98304, v84
  s_and_b32 s65, s52, 1
  s_lshl_b32 s65, s65, 3
  v_xor_b32 v5, v4, v2
  v_xor_b32 v5, s65, v5
  v_lshlrev_b32 v5, 4, v5
  v_lshl_add_u32 v251, v2, 8, v5
  v_xor_b32 v252, 64, v251
  v_lshrrev_b32 v5, 2, v255
  v_lshlrev_b32 v6, 4, v12
  v_lshl_add_u32 v253, v5, 8, v6
  v_lshl_add_u32 v5, v9, 2, v10
  v_lshlrev_b32 v5, 6, v5
  v_lshl_add_u32 v5, v11, 5, v5
  v_lshl_add_u32 v248, v12, 3, v5
  v_xor_b32 v5, v4, v9
  v_lshlrev_b32 v5, 4, v5
  v_lshl_add_u32 v5, v1, 8, v5
  v_bfe_u32 v6, v255, 3, 2
  v_lshl_add_u32 v232, v6, 12, v5
  v_xor_b32 v233, 32, v232
  v_xor_b32 v234, 64, v232
  v_xor_b32 v235, 96, v232
  v_xor_b32 v236, 128, v232
  v_xor_b32 v237, 160, v232
  v_xor_b32 v238, 192, v232
  v_xor_b32 v239, 224, v232
  v_lshlrev_b32 v5, 1, v10
  v_and_b32 v5, 2, v5
  v_lshrrev_b32 v6, 1, v10
  v_or_b32 v5, v5, v6
  v_lshl_add_u32 v5, v5, 2, v12
  v_lshlrev_b32 v5, 4, v5
  v_lshl_add_u32 v5, v11, 12, v5
  v_add_u32 v87, 133632, v5
  s_lshl_b32 s72, s54, 19
  s_add_u32 s72, s72, 393216
  s_lshl_b32 s65, s52, 11
  s_add_u32 s59, s72, s65
  s_lshl_b32 s65, s52, 14
  s_or_b32 s72, s72, s65
  s_and_b32 s61, s2, 7
  s_lshr_b32 s62, s2, 6
  s_bfe_u32 s63, s2, 0x30003
  s_lshl_b32 s60, s63, 19
  s_lshl_b32 s65, s52, 16
  s_add_u32 s60, s60, s65
  s_add_u32 s60, s60, 20971520
  s_lshl_b32 s100, s61, 2
  s_add_u32 s100, s100, s62
  s_lshl_b32 s77, s100, 17
  s_lshl_b32 s65, s52, 13
  s_add_u32 s77, s77, s65
  s_add_u32 s78, s77, 65536
  s_lshl_b32 s81, s53, 3
  s_add_u32 s81, s81, s52
  s_lshl_b32 s81, s81, 5
  s_add_u32 s81, s81, s54
  s_lshl_b32 s81, s81, 11
  s_lshl_b32 s3, s100, 3
  s_add_u32 s3, s3, s52
  s_lshl_b32 s3, s3, 7
  s_lshl_b32 s101, s100, 16
  s_lshl_b32 s65, s63, 7
  s_add_u32 s101, s101, s65
  s_mul_i32 s73, s61, 24
  s_lshr_b32 s65, s2, 3
  s_add_u32 s73, s73, s65
  s_cmp_lt_u32 s65, 24
  s_cselect_b32 s73, s73, 255
  s_cmp_ge_u32 s52, 4
  s_cbranch_scc0 L_x0b
  s_add_u32 m0, s55, 32768
  s_xor_b32 s64, s57, 0
  buffer_load_dwordx4 v65, s[4:7], s64 offen offset:0 lds
  s_add_u32 m0, s55, 32768
  s_xor_b32 s64, s57, 0
  buffer_load_dwordx4 v66, s[4:7], s64 offen offset:1024 lds
  s_add_u32 m0, s55, 32768
  s_xor_b32 s64, s57, 0
  buffer_load_dwordx4 v67, s[4:7], s64 offen offset:2048 lds
  s_add_u32 m0, s55, 32768
  s_xor_b32 s64, s57, 0
  buffer_load_dwordx4 v68, s[4:7], s64 offen offset:3072 lds
L_x0b:
  s_cmp_lg_u32 s52, 7
  s_cbranch_scc1 L_nopf
  s_getpc_b64 s[70:71]
  s_bfe_u32 s65, s2, 0x20003
  s_lshl_b32 s65, s65, 13
  v_lshlrev_b32 v5, 7, v255
  v_add_u32 v5, s65, v5
  global_load_dword v212, v5, s[70:71]
L_nopf:
  s_waitcnt vmcnt(6)
  s_or_b32 s65, s2, s52
  s_cmp_lg_u32 s65, 0
  s_cbranch_scc1 L_non1
  s_waitcnt lgkmcnt(0)
  s_add_u32 s83, s83, 1
  s_bitset1_b32 s83, 31
  v_mov_b32 v96, s83
  s_mov_b64 exec, 1
  buffer_store_dword v96, v91, s[28:31], 0 offen sc1
  s_mov_b64 exec, -1
L_non1:
  v_lshlrev_b32 v156, 16, v216
  v_and_b32 v157, 0xffff0000, v216
  v_lshlrev_b32 v158, 16, v217
  v_and_b32 v159, 0xffff0000, v217
  v_lshlrev_b32 v160, 16, v218
  v_and_b32 v161, 0xffff0000, v218
  v_lshlrev_b32 v162, 16, v219
  v_and_b32 v163, 0xffff0000, v219
  v_readfirstlane_b32 s65, v156
  v_lshlrev_b32 v164, 16, v220
  v_and_b32 v165, 0xffff0000, v220
  v_lshlrev_b32 v166, 16, v221
  v_and_b32 v167, 0xffff0000, v221
  v_lshlrev_b32 v168, 16, v222
  v_and_b32 v169, 0xffff0000, v222
  v_lshlrev_b32 v170, 16, v223
  v_and_b32 v171, 0xffff0000, v223
  v_subrev_f32 v156, s65, v156
  v_subrev_f32 v157, s65, v157
  v_subrev_f32 v158, s65, v158
  v_subrev_f32 v159, s65, v159
  v_subrev_f32 v160, s65, v160
  v_subrev_f32 v161, s65, v161
  v_subrev_f32 v162, s65, v162
  v_subrev_f32 v163, s65, v163
  v_add_f32 v172, v156, v157
  v_mul_f32 v173, v156, v156
  v_mul_f32 v174, v156, v164
  v_add_f32 v175, v164, v165
  v_fmac_f32 v173, v157, v157
  v_fmac_f32 v174, v157, v165
  v_add_f32 v172, v172, v158
  v_fmac_f32 v173, v158, v158
  v_fmac_f32 v174, v158, v166
  v_add_f32 v175, v175, v166
  v_add_f32 v172, v172, v159
  v_fmac_f32 v173, v159, v159
  v_fmac_f32 v174, v159, v167
  v_add_f32 v175, v175, v167
  v_add_f32 v172, v172, v160
  v_fmac_f32 v173, v160, v160
  v_fmac_f32 v174, v160, v168
  v_add_f32 v175, v175, v168
  v_add_f32 v172, v172, v161
  v_fmac_f32 v173, v161, v161
  v_fmac_f32 v174, v161, v169
  v_add_f32 v175, v175, v169
  v_add_f32 v172, v172, v162
  v_fmac_f32 v173, v162, v162
  v_fmac_f32 v174, v162, v170
  v_add_f32 v175, v175, v170
  v_add_f32 v172, v172, v163
  v_fmac_f32 v173, v163, v163
  v_fmac_f32 v174, v163, v171
  v_add_f32 v175, v175, v171
  v_add_f32_dpp v172, v172, v172 row_ror:8 row_mask:0xf bank_mask:0xf
  v_add_f32_dpp v173, v173, v173 row_ror:8 row_mask:0xf bank_mask:0xf
  v_add_f32_dpp v174, v174, v174 row_ror:8 row_mask:0xf bank_mask:0xf
  v_add_f32_dpp v175, v175, v175 row_ror:8 row_mask:0xf bank_mask:0xf
  v_add_f32_dpp v172, v172, v172 row_ror:4 row_mask:0xf bank_mask:0xf
  v_add_f32_dpp v173, v173, v173 row_ror:4 row_mask:0xf bank_mask:0xf
  v_add_f32_dpp v174, v174, v174 row_ror:4 row_mask:0xf bank_mask:0xf
  v_add_f32_dpp v175, v175, v175 row_ror:4 row_mask:0xf bank_mask:0xf
  v_add_f32_dpp v172, v172, v172 row_ror:2 row_mask:0xf bank_mask:0xf
  v_add_f32_dpp v173, v173, v173 row_ror:2 row_mask:0xf bank_mask:0xf
  v_add_f32_dpp v174, v174, v174 row_ror:2 row_mask:0xf bank_mask:0xf
  v_add_f32_dpp v175, v175, v175 row_ror:2 row_mask:0xf bank_mask:0xf
  v_add_f32_dpp v172, v172, v172 row_ror:1 row_mask:0xf bank_mask:0xf
  v_add_f32_dpp v173, v173, v173 row_ror:1 row_mask:0xf bank_mask:0xf
  v_add_f32_dpp v174, v174, v174 row_ror:1 row_mask:0xf bank_mask:0xf
  v_add_f32_dpp v175, v175, v175 row_ror:1 row_mask:0xf bank_mask:0xf
  v_add_f32_dpp v172, v172, v172 row_bcast:15 row_mask:0xa bank_mask:0xf
  v_add_f32_dpp v173, v173, v173 row_bcast:15 row_mask:0xa bank_mask:0xf
  v_add_f32_dpp v174, v174, v174 row_bcast:15 row_mask:0xa bank_mask:0xf
  v_add_f32_dpp v175, v175, v175 row_bcast:15 row_mask:0xa bank_mask:0xf
  v_add_f32_dpp v172, v172, v172 row_bcast:31 row_mask:0xc bank_mask:0xf
  v_add_f32_dpp v173, v173, v173 row_bcast:31 row_mask:0xc bank_mask:0xf
  v_add_f32_dpp v174, v174, v174 row_bcast:31 row_mask:0xc bank_mask:0xf
  v_add_f32_dpp v175, v175, v175 row_bcast:31 row_mask:0xc bank_mask:0xf
  v_mul_f32 v99, 0x3b000000, v172
  v_mul_f32 v173, 0x3b000000, v173
  v_fma_f32 v172, -v99, v99, v173
  v_max_f32 v172, 0, v172
  v_add_f32 v99, s65, v99
  v_cvt_pk_bf16_f32 v92, v99, v99
  v_and_b32 v92, 0xffff0000, v92
  v_cvt_pk_bf16_f32 v172, v172, v172
  v_and_b32 v172, 0xffff0000, v172
  v_subrev_f32 v99, s65, v92
  v_add_f32 v172, 0x3727c5ac, v172
  v_cvt_pk_bf16_f32 v172, v172, v172
  v_and_b32 v172, 0xffff0000, v172
  v_sqrt_f32 v172, v172
  v_fma_f32 v174, -v99, v175, v174
  v_cvt_pk_bf16_f32 v172, v172, v172
  v_and_b32 v172, 0xffff0000, v172
  v_rcp_f32 v93, v172
  s_nop 0
  v_mul_f32 v172, v174, v93
  v_cvt_pk_bf16_f32 v172, v172, v172
  v_and_b32 v172, 0xffff0000, v172
  v_ashrrev_i32 v173, 31, v172
  v_and_b32 v173, 0x7fff0000, v173
  v_or_b32 v173, 0x80000000, v173
  v_xor_b32 v172, v172, v173
  s_sub_u32 s69, 2047, s66
  v_or_b32 v172, s69, v172
  s_lshl_b32 s69, s66, 3
  s_add_u32 s69, s69, 16777216
  s_lshl_b32 s68, s52, 2
  s_add_u32 s68, s68, 134144
  v_mov_b32 v173, s68
  s_add_u32 m0, s55, 65536
  s_xor_b32 s64, s57, 128
  buffer_load_dwordx4 v65, s[4:7], s64 offen offset:0 lds
  s_add_u32 m0, s55, 65536
  s_xor_b32 s64, s57, 128
  buffer_load_dwordx4 v66, s[4:7], s64 offen offset:1024 lds
  s_add_u32 m0, s55, 65536
  s_xor_b32 s64, s57, 128
  buffer_load_dwordx4 v67, s[4:7], s64 offen offset:2048 lds
  s_add_u32 m0, s55, 65536
  s_xor_b32 s64, s57, 128
  buffer_load_dwordx4 v68, s[4:7], s64 offen offset:3072 lds
  s_add_u32 m0, s55, 100352
  s_xor_b32 s64, s58, 524288
  buffer_load_dwordx4 v69, s[8:11], s64 offen offset:0 lds
  s_add_u32 m0, s55, 100352
  s_xor_b32 s64, s58, 524288
  buffer_load_dwordx4 v70, s[8:11], s64 offen offset:1024 lds
  s_lshl_b32 s68, s52, 8
  s_add_u32 s68, s68, s56
  s_lshl_b32 s68, s68, 7
  s_add_u32 s68, s68, 16809984
  s_cmp_lt_u32 s52, 3
  s_cselect_b32 s68, s68, 0x7f000000
  s_mov_b32 exec_lo, 0
  s_brev_b32 exec_hi, 1
  buffer_store_dword v91, v91, s[24:27], s68 offen sc1
  buffer_store_dwordx2 v[92:93], v91, s[24:27], s69 offen sc1
  s_mov_b64 exec, -1
  s_mov_b32 exec_lo, 0
  s_brev_b32 exec_hi, 1
  ds_write_b32 v173, v172
  s_mov_b64 exec, -1
  v_mov_b32 v94, 0
  v_mov_b32 v95, 0
  s_waitcnt vmcnt(8)
  ds_read_b128 v[112:115], v71 offset:0
  ds_read_b128 v[116:119], v72 offset:0
  ds_read_b128 v[120:123], v73 offset:0
  ds_read_b128 v[124:127], v74 offset:0
  s_waitcnt lgkmcnt(0)
  s_barrier
  ds_read_b64_tr_b16 v[176:177], v224 offset:0
  ds_read_b64_tr_b16 v[178:179], v224 offset:1024
  ds_read_b64_tr_b16 v[180:181], v225 offset:0
  ds_read_b64_tr_b16 v[182:183], v225 offset:1024
  ds_read_b64_tr_b16 v[184:185], v226 offset:0
  ds_read_b64_tr_b16 v[186:187], v226 offset:1024
  ds_read_b64_tr_b16 v[188:189], v227 offset:0
  ds_read_b64_tr_b16 v[190:191], v227 offset:1024
  ds_read_b64_tr_b16 v[192:193], v224 offset:8192
  ds_read_b64_tr_b16 v[194:195], v224 offset:9216
  ds_read_b64_tr_b16 v[196:197], v225 offset:8192
  ds_read_b64_tr_b16 v[198:199], v225 offset:9216
  s_waitcnt lgkmcnt(10)
  v_mfma_f32_32x32x16_bf16 v[0:15], v[176:179], v[112:115], 0
  ds_read_b64_tr_b16 v[200:201], v226 offset:8192
  ds_read_b64_tr_b16 v[202:203], v226 offset:9216
  s_add_u32 m0, s55, 131072
  s_xor_b32 s64, s58, 1048576
  buffer_load_dwordx4 v69, s[8:11], s64 offen offset:0 lds
  ds_read_b64_tr_b16 v[144:145], v85 offset:0
  ds_read_b64_tr_b16 v[146:147], v85 offset:1024
  ds_read_b64_tr_b16 v[148:149], v86 offset:0
  ds_read_b64_tr_b16 v[150:151], v86 offset:1024
  s_waitcnt lgkmcnt(14)
  v_mfma_f32_32x32x16_bf16 v[16:31], v[180:183], v[112:115], 0
  ds_read_b64_tr_b16 v[204:205], v227 offset:8192
  ds_read_b64_tr_b16 v[206:207], v227 offset:9216
  s_add_u32 m0, s55, 131072
  s_xor_b32 s64, s58, 1048576
  buffer_load_dwordx4 v70, s[8:11], s64 offen offset:1024 lds
  s_waitcnt lgkmcnt(2)
  v_lshlrev_b32 v152, 16, v144
  v_and_b32 v153, 0xffff0000, v144
  v_add_f32 v94, v94, v152
  v_mfma_f32_32x32x16_bf16 v[32:47], v[184:187], v[112:115], 0
  ds_read_b64_tr_b16 v[176:177], v224 offset:16384
  ds_read_b64_tr_b16 v[178:179], v224 offset:17408
  s_add_u32 m0, s55, 0
  s_xor_b32 s64, s58, 1572864
  buffer_load_dwordx4 v69, s[8:11], s64 offen offset:0 lds
  v_add_f32 v94, v94, v153
  v_lshlrev_b32 v154, 16, v145
  v_mfma_f32_32x32x16_bf16 v[48:63], v[188:191], v[112:115], 0
  ds_read_b64_tr_b16 v[180:181], v225 offset:16384
  ds_read_b64_tr_b16 v[182:183], v225 offset:17408
  s_add_u32 m0, s55, 0
  s_xor_b32 s64, s58, 1572864
  buffer_load_dwordx4 v70, s[8:11], s64 offen offset:1024 lds
  v_and_b32 v155, 0xffff0000, v145
  v_add_f32 v94, v94, v154
  v_mfma_f32_32x32x16_bf16 v[0:15], v[192:195], v[116:119], v[0:15]
  ds_read_b64_tr_b16 v[184:185], v226 offset:16384
  ds_read_b64_tr_b16 v[186:187], v226 offset:17408
  s_add_u32 m0, s55, 32768
  s_xor_b32 s64, s57, 256
  buffer_load_dwordx4 v65, s[4:7], s64 offen offset:0 lds
  v_add_f32 v94, v94, v155
  v_lshlrev_b32 v152, 16, v146
  v_mfma_f32_32x32x16_bf16 v[16:31], v[196:199], v[116:119], v[16:31]
  ds_read_b64_tr_b16 v[188:189], v227 offset:16384
  ds_read_b64_tr_b16 v[190:191], v227 offset:17408
  s_add_u32 m0, s55, 32768
  s_xor_b32 s64, s57, 256
  buffer_load_dwordx4 v66, s[4:7], s64 offen offset:1024 lds
  v_and_b32 v153, 0xffff0000, v146
  v_add_f32 v94, v94, v152
  v_mfma_f32_32x32x16_bf16 v[32:47], v[200:203], v[116:119], v[32:47]
  ds_read_b64_tr_b16 v[192:193], v224 offset:24576
  ds_read_b64_tr_b16 v[194:195], v224 offset:25600
  s_add_u32 m0, s55, 32768
  s_xor_b32 s64, s57, 256
  buffer_load_dwordx4 v67, s[4:7], s64 offen offset:2048 lds
  v_add_f32 v94, v94, v153
  v_lshlrev_b32 v154, 16, v147
  s_waitcnt lgkmcnt(10)
  v_mfma_f32_32x32x16_bf16 v[48:63], v[204:207], v[116:119], v[48:63]
  ds_read_b64_tr_b16 v[196:197], v225 offset:24576
  ds_read_b64_tr_b16 v[198:199], v225 offset:25600
  s_add_u32 m0, s55, 32768
  s_xor_b32 s64, s57, 256
  buffer_load_dwordx4 v68, s[4:7], s64 offen offset:3072 lds
  v_and_b32 v155, 0xffff0000, v147
  v_add_f32 v94, v94, v154
  s_waitcnt lgkmcnt(10)
  v_mfma_f32_32x32x16_bf16 v[0:15], v[176:179], v[120:123], v[0:15]
  ds_read_b64_tr_b16 v[200:201], v226 offset:24576
  ds_read_b64_tr_b16 v[202:203], v226 offset:25600
  s_add_u32 m0, s55, 2048
  s_xor_b32 s64, s58, 2097152
  buffer_load_dwordx4 v69, s[8:11], s64 offen offset:0 lds
  v_add_f32 v94, v94, v155
  v_lshlrev_b32 v152, 16, v148
  v_and_b32 v153, 0xffff0000, v148
  s_waitcnt lgkmcnt(10)
  v_mfma_f32_32x32x16_bf16 v[16:31], v[180:183], v[120:123], v[16:31]
  ds_read_b64_tr_b16 v[204:205], v227 offset:24576
  ds_read_b64_tr_b16 v[206:207], v227 offset:25600
  s_waitcnt vmcnt(13)
  ds_read_b128 v[128:131], v71 offset:32768
  ds_read_b128 v[132:135], v72 offset:32768
  ds_read_b128 v[136:139], v73 offset:32768
  ds_read_b128 v[140:143], v74 offset:32768
  s_add_u32 m0, s55, 2048
  s_xor_b32 s64, s58, 2097152
  buffer_load_dwordx4 v70, s[8:11], s64 offen offset:1024 lds
  v_add_f32 v95, v95, v152
  v_add_f32 v95, v95, v153
  s_waitcnt lgkmcnt(14)
  v_mfma_f32_32x32x16_bf16 v[32:47], v[184:187], v[120:123], v[32:47]
  v_lshlrev_b32 v154, 16, v149
  v_and_b32 v155, 0xffff0000, v149
  s_waitcnt lgkmcnt(12)
  v_mfma_f32_32x32x16_bf16 v[48:63], v[188:191], v[120:123], v[48:63]
  v_add_f32 v95, v95, v154
  v_add_f32 v95, v95, v155
  s_waitcnt lgkmcnt(10)
  v_mfma_f32_32x32x16_bf16 v[0:15], v[192:195], v[124:127], v[0:15]
  v_lshlrev_b32 v152, 16, v150
  v_and_b32 v153, 0xffff0000, v150
  s_waitcnt lgkmcnt(8)
  v_mfma_f32_32x32x16_bf16 v[16:31], v[196:199], v[124:127], v[16:31]
  s_waitcnt vmcnt(12)
  s_waitcnt lgkmcnt(0)
  s_barrier
  ds_read_b64_tr_b16 v[176:177], v224 offset:2048
  ds_read_b64_tr_b16 v[178:179], v224 offset:3072
  ds_read_b64_tr_b16 v[180:181], v225 offset:2048
  ds_read_b64_tr_b16 v[182:183], v225 offset:3072
  ds_read_b64_tr_b16 v[184:185], v226 offset:2048
  ds_read_b64_tr_b16 v[186:187], v226 offset:3072
  ds_read_b64_tr_b16 v[188:189], v227 offset:2048
  ds_read_b64_tr_b16 v[190:191], v227 offset:3072
  s_add_u32 m0, s55, 65536
  s_xor_b32 s64, s57, 384
  buffer_load_dwordx4 v65, s[4:7], s64 offen offset:0 lds
  v_add_f32 v95, v95, v152
  v_add_f32 v95, v95, v153
  v_mfma_f32_32x32x16_bf16 v[32:47], v[200:203], v[124:127], v[32:47]
  ds_read_b64_tr_b16 v[192:193], v224 offset:10240
  ds_read_b64_tr_b16 v[194:195], v224 offset:11264
  v_lshlrev_b32 v154, 16, v151
  v_and_b32 v155, 0xffff0000, v151
  v_mfma_f32_32x32x16_bf16 v[48:63], v[204:207], v[124:127], v[48:63]
  ds_read_b64_tr_b16 v[196:197], v225 offset:10240
  ds_read_b64_tr_b16 v[198:199], v225 offset:11264
  s_add_u32 m0, s55, 65536
  s_xor_b32 s64, s57, 384
  buffer_load_dwordx4 v66, s[4:7], s64 offen offset:1024 lds
  v_add_f32 v95, v95, v154
  v_add_f32 v95, v95, v155
  s_waitcnt lgkmcnt(10)
  v_mfma_f32_32x32x16_bf16 v[0:15], v[176:179], v[128:131], v[0:15]
  ds_read_b64_tr_b16 v[200:201], v226 offset:10240
  ds_read_b64_tr_b16 v[202:203], v226 offset:11264
  ds_read_b64_tr_b16 v[144:145], v85 offset:2048
  ds_read_b64_tr_b16 v[146:147], v85 offset:3072
  ds_read_b64_tr_b16 v[148:149], v86 offset:2048
  ds_read_b64_tr_b16 v[150:151], v86 offset:3072
  s_waitcnt lgkmcnt(14)
  v_mfma_f32_32x32x16_bf16 v[16:31], v[180:183], v[128:131], v[16:31]
  ds_read_b64_tr_b16 v[204:205], v227 offset:10240
  ds_read_b64_tr_b16 v[206:207], v227 offset:11264
  s_waitcnt lgkmcnt(2)
  v_lshlrev_b32 v152, 16, v144
  v_and_b32 v153, 0xffff0000, v144
  v_add_f32 v94, v94, v152
  v_mfma_f32_32x32x16_bf16 v[32:47], v[184:187], v[128:131], v[32:47]
  ds_read_b64_tr_b16 v[176:177], v224 offset:18432
  ds_read_b64_tr_b16 v[178:179], v224 offset:19456
  s_add_u32 m0, s55, 65536
  s_xor_b32 s64, s57, 384
  buffer_load_dwordx4 v67, s[4:7], s64 offen offset:2048 lds
  v_add_f32 v94, v94, v153
  v_lshlrev_b32 v154, 16, v145
  v_mfma_f32_32x32x16_bf16 v[48:63], v[188:191], v[128:131], v[48:63]
  ds_read_b64_tr_b16 v[180:181], v225 offset:18432
  ds_read_b64_tr_b16 v[182:183], v225 offset:19456
  v_and_b32 v155, 0xffff0000, v145
  v_add_f32 v94, v94, v154
  v_mfma_f32_32x32x16_bf16 v[0:15], v[192:195], v[132:135], v[0:15]
  ds_read_b64_tr_b16 v[184:185], v226 offset:18432
  ds_read_b64_tr_b16 v[186:187], v226 offset:19456
  s_add_u32 m0, s55, 65536
  s_xor_b32 s64, s57, 384
  buffer_load_dwordx4 v68, s[4:7], s64 offen offset:3072 lds
  v_add_f32 v94, v94, v155
  v_lshlrev_b32 v152, 16, v146
  v_mfma_f32_32x32x16_bf16 v[16:31], v[196:199], v[132:135], v[16:31]
  ds_read_b64_tr_b16 v[188:189], v227 offset:18432
  ds_read_b64_tr_b16 v[190:191], v227 offset:19456
  v_and_b32 v153, 0xffff0000, v146
  v_add_f32 v94, v94, v152
  v_mfma_f32_32x32x16_bf16 v[32:47], v[200:203], v[132:135], v[32:47]
  ds_read_b64_tr_b16 v[192:193], v224 offset:26624
  ds_read_b64_tr_b16 v[194:195], v224 offset:27648
  v_add_f32 v94, v94, v153
  v_lshlrev_b32 v154, 16, v147
  s_waitcnt lgkmcnt(10)
  v_mfma_f32_32x32x16_bf16 v[48:63], v[204:207], v[132:135], v[48:63]
  ds_read_b64_tr_b16 v[196:197], v225 offset:26624
  ds_read_b64_tr_b16 v[198:199], v225 offset:27648
  v_and_b32 v155, 0xffff0000, v147
  v_add_f32 v94, v94, v154
  s_waitcnt lgkmcnt(10)
  v_mfma_f32_32x32x16_bf16 v[0:15], v[176:179], v[136:139], v[0:15]
  ds_read_b64_tr_b16 v[200:201], v226 offset:26624
  ds_read_b64_tr_b16 v[202:203], v226 offset:27648
  v_add_f32 v94, v94, v155
  v_lshlrev_b32 v152, 16, v148
  v_and_b32 v153, 0xffff0000, v148
  s_waitcnt lgkmcnt(10)
  v_mfma_f32_32x32x16_bf16 v[16:31], v[180:183], v[136:139], v[16:31]
  ds_read_b64_tr_b16 v[204:205], v227 offset:26624
  ds_read_b64_tr_b16 v[206:207], v227 offset:27648
  s_waitcnt vmcnt(6)
  ds_read_b128 v[112:115], v71 offset:0
  ds_read_b128 v[116:119], v72 offset:0
  ds_read_b128 v[120:123], v73 offset:0
  ds_read_b128 v[124:127], v74 offset:0
  v_add_f32 v95, v95, v152
  v_add_f32 v95, v95, v153
  s_waitcnt lgkmcnt(14)
  v_mfma_f32_32x32x16_bf16 v[32:47], v[184:187], v[136:139], v[32:47]
  v_lshlrev_b32 v154, 16, v149
  v_and_b32 v155, 0xffff0000, v149
  s_waitcnt lgkmcnt(12)
  v_mfma_f32_32x32x16_bf16 v[48:63], v[188:191], v[136:139], v[48:63]
  v_add_f32 v95, v95, v154
  v_add_f32 v95, v95, v155
  s_waitcnt lgkmcnt(10)
  v_mfma_f32_32x32x16_bf16 v[0:15], v[192:195], v[140:143], v[0:15]
  v_lshlrev_b32 v152, 16, v150
  v_and_b32 v153, 0xffff0000, v150
  s_waitcnt lgkmcnt(8)
  v_mfma_f32_32x32x16_bf16 v[16:31], v[196:199], v[140:143], v[16:31]
  s_waitcnt lgkmcnt(0)
  s_barrier
  buffer_load_dword v213, v91, s[28:31], 0 offen sc1
  ds_read_b64_tr_b16 v[176:177], v224 offset:32768
  ds_read_b64_tr_b16 v[178:179], v224 offset:33792
  ds_read_b64_tr_b16 v[180:181], v225 offset:32768
  ds_read_b64_tr_b16 v[182:183], v225 offset:33792
  ds_read_b64_tr_b16 v[184:185], v226 offset:32768
  ds_read_b64_tr_b16 v[186:187], v226 offset:33792
  ds_read_b64_tr_b16 v[188:189], v227 offset:32768
  ds_read_b64_tr_b16 v[190:191], v227 offset:33792
  s_add_u32 m0, s55, 98304
  s_xor_b32 s64, s58, 2621440
  buffer_load_dwordx4 v69, s[8:11], s64 offen offset:0 lds
  v_add_f32 v95, v95, v152
  v_add_f32 v95, v95, v153
  v_mfma_f32_32x32x16_bf16 v[32:47], v[200:203], v[140:143], v[32:47]
  ds_read_b64_tr_b16 v[192:193], v224 offset:40960
  ds_read_b64_tr_b16 v[194:195], v224 offset:41984
  s_add_u32 m0, s55, 98304
  s_xor_b32 s64, s58, 2621440
  buffer_load_dwordx4 v70, s[8:11], s64 offen offset:1024 lds
  v_lshlrev_b32 v154, 16, v151
  v_and_b32 v155, 0xffff0000, v151
  v_mfma_f32_32x32x16_bf16 v[48:63], v[204:207], v[140:143], v[48:63]
  ds_read_b64_tr_b16 v[196:197], v225 offset:40960
  ds_read_b64_tr_b16 v[198:199], v225 offset:41984
  s_add_u32 m0, s55, 100352
  s_xor_b32 s64, s58, 3145728
  buffer_load_dwordx4 v69, s[8:11], s64 offen offset:0 lds
  v_add_f32 v95, v95, v154
  v_add_f32 v95, v95, v155
  s_waitcnt lgkmcnt(10)
  v_mfma_f32_32x32x16_bf16 v[0:15], v[176:179], v[112:115], v[0:15]
  ds_read_b64_tr_b16 v[200:201], v226 offset:40960
  ds_read_b64_tr_b16 v[202:203], v226 offset:41984
  s_add_u32 m0, s55, 100352
  s_xor_b32 s64, s58, 3145728
  buffer_load_dwordx4 v70, s[8:11], s64 offen offset:1024 lds
  ds_read_b64_tr_b16 v[144:145], v85 offset:32768
  ds_read_b64_tr_b16 v[146:147], v85 offset:33792
  ds_read_b64_tr_b16 v[148:149], v86 offset:32768
  ds_read_b64_tr_b16 v[150:151], v86 offset:33792
  s_waitcnt lgkmcnt(14)
  v_mfma_f32_32x32x16_bf16 v[16:31], v[180:183], v[112:115], v[16:31]
  ds_read_b64_tr_b16 v[204:205], v227 offset:40960
  ds_read_b64_tr_b16 v[206:207], v227 offset:41984
  s_waitcnt lgkmcnt(2)
  v_lshlrev_b32 v152, 16, v144
  v_and_b32 v153, 0xffff0000, v144
  v_add_f32 v94, v94, v152
  v_add_f32 v94, v94, v153
  v_lshlrev_b32 v154, 16, v145
  v_and_b32 v155, 0xffff0000, v145
  v_add_f32 v94, v94, v154
  v_mfma_f32_32x32x16_bf16 v[32:47], v[184:187], v[112:115], v[32:47]
  ds_read_b64_tr_b16 v[176:177], v224 offset:49152
  ds_read_b64_tr_b16 v[178:179], v224 offset:50176
  s_add_u32 m0, s55, 32768
  s_xor_b32 s64, s57, 512
  buffer_load_dwordx4 v65, s[4:7], s64 offen offset:0 lds
  v_add_f32 v94, v94, v155
  v_lshlrev_b32 v152, 16, v146
  v_and_b32 v153, 0xffff0000, v146
  v_add_f32 v94, v94, v152
  v_add_f32 v94, v94, v153
  v_lshlrev_b32 v154, 16, v147
  v_mfma_f32_32x32x16_bf16 v[48:63], v[188:191], v[112:115], v[48:63]
  ds_read_b64_tr_b16 v[180:181], v225 offset:49152
  ds_read_b64_tr_b16 v[182:183], v225 offset:50176
  s_add_u32 m0, s55, 32768
  s_xor_b32 s64, s57, 512
  buffer_load_dwordx4 v66, s[4:7], s64 offen offset:1024 lds
  v_and_b32 v155, 0xffff0000, v147
  v_add_f32 v94, v94, v154
  v_add_f32 v94, v94, v155
  v_lshlrev_b32 v152, 16, v148
  v_and_b32 v153, 0xffff0000, v148
  v_add_f32 v95, v95, v152
  v_add_f32 v95, v95, v153
  v_mfma_f32_32x32x16_bf16 v[0:15], v[192:195], v[116:119], v[0:15]
  ds_read_b64_tr_b16 v[184:185], v226 offset:49152
  ds_read_b64_tr_b16 v[186:187], v226 offset:50176
  s_add_u32 m0, s55, 32768
  s_xor_b32 s64, s57, 512
  buffer_load_dwordx4 v67, s[4:7], s64 offen offset:2048 lds
  v_lshlrev_b32 v154, 16, v149
  v_and_b32 v155, 0xffff0000, v149
  v_add_f32 v95, v95, v154
  v_add_f32 v95, v95, v155
  v_lshlrev_b32 v152, 16, v150
  v_and_b32 v153, 0xffff0000, v150
  v_mfma_f32_32x32x16_bf16 v[16:31], v[196:199], v[116:119], v[16:31]
  ds_read_b64_tr_b16 v[188:189], v227 offset:49152
  ds_read_b64_tr_b16 v[190:191], v227 offset:50176
  s_add_u32 m0, s55, 32768
  s_xor_b32 s64, s57, 512
  buffer_load_dwordx4 v68, s[4:7], s64 offen offset:3072 lds
  v_add_f32 v95, v95, v152
  v_add_f32 v95, v95, v153
  v_lshlrev_b32 v154, 16, v151
  v_and_b32 v155, 0xffff0000, v151
  v_add_f32 v95, v95, v154
  v_add_f32 v95, v95, v155
  v_mfma_f32_32x32x16_bf16 v[32:47], v[200:203], v[116:119], v[32:47]
  ds_read_b64_tr_b16 v[192:193], v224 offset:57344
  ds_read_b64_tr_b16 v[194:195], v224 offset:58368
  ds_read_b64_tr_b16 v[144:145], v83 offset:0
  ds_read_b64_tr_b16 v[146:147], v83 offset:1024
  ds_read_b64_tr_b16 v[148:149], v84 offset:0
  ds_read_b64_tr_b16 v[150:151], v84 offset:1024
  s_waitcnt lgkmcnt(14)
  v_mfma_f32_32x32x16_bf16 v[48:63], v[204:207], v[116:119], v[48:63]
  ds_read_b64_tr_b16 v[196:197], v225 offset:57344
  ds_read_b64_tr_b16 v[198:199], v225 offset:58368
  s_mov_b32 s68, 0x7f000000
  s_cmp_lg_u32 s52, 0
  s_cbranch_scc1 Lk_1
  s_waitcnt vmcnt(8)
  s_mov_b32 s80, 0
Lspin_2:
  v_cmp_ne_u32 vcc, 0, v213
  s_nop 0
  s_cmp_eq_u64 vcc, -1
  s_cbranch_scc1 Lok_3
  s_sleep 8
  buffer_load_dword v213, v91, s[28:31], 0 offen sc1
  s_waitcnt vmcnt(0)
  s_add_u32 s80, s80, 1
  s_cmp_lt_u32 s80, 0x80000
  s_cbranch_scc1 Lspin_2
Lok_3:
  v_and_b32 v96, 7, v255
  v_lshlrev_b32 v96, 2, v96
  v_add_u32 v96, 134144, v96
  ds_read_b32 v96, v96
  v_mov_b32 v97, v213
  s_waitcnt lgkmcnt(0)
  v_max_u32_dpp v96, v96, v96 row_ror:4 row_mask:0xf bank_mask:0xf
  s_nop 1
  v_max_u32_dpp v96, v96, v96 row_ror:2 row_mask:0xf bank_mask:0xf
  s_nop 1
  v_max_u32_dpp v96, v96, v96 row_ror:1 row_mask:0xf bank_mask:0xf
  s_nop 1
  s_lshl_b32 s68, s56, 3
  s_add_u32 s68, s68, 16793600
Lk_1:
  s_mov_b64 exec, 1
  buffer_store_dwordx2 v[96:97], v91, s[24:27], s68 offen sc1
  s_mov_b64 exec, -1
  s_waitcnt lgkmcnt(2)
  v_lshlrev_b32 v152, 16, v144
  v_and_b32 v153, 0xffff0000, v144
  v_add_f32 v94, v94, v152
  v_add_f32 v94, v94, v153
  v_mfma_f32_32x32x16_bf16 v[0:15], v[176:179], v[120:123], v[0:15]
  ds_read_b64_tr_b16 v[200:201], v226 offset:57344
  ds_read_b64_tr_b16 v[202:203], v226 offset:58368
  v_lshlrev_b32 v154, 16, v145
  v_and_b32 v155, 0xffff0000, v145
  v_add_f32 v94, v94, v154
  v_add_f32 v94, v94, v155
  v_mfma_f32_32x32x16_bf16 v[16:31], v[180:183], v[120:123], v[16:31]
  ds_read_b64_tr_b16 v[204:205], v227 offset:57344
  ds_read_b64_tr_b16 v[206:207], v227 offset:58368
  s_waitcnt vmcnt(10)
  ds_read_b128 v[128:131], v71 offset:32768
  ds_read_b128 v[132:135], v72 offset:32768
  ds_read_b128 v[136:139], v73 offset:32768
  ds_read_b128 v[140:143], v74 offset:32768
  v_lshlrev_b32 v152, 16, v146
  v_and_b32 v153, 0xffff0000, v146
  v_add_f32 v94, v94, v152
  v_mfma_f32_32x32x16_bf16 v[32:47], v[184:187], v[120:123], v[32:47]
  ds_read_b64_tr_b16 v[176:177], v75 offset:0
  ds_read_b64_tr_b16 v[178:179], v75 offset:1024
  v_add_f32 v94, v94, v153
  v_lshlrev_b32 v154, 16, v147
  v_and_b32 v155, 0xffff0000, v147
  v_add_f32 v94, v94, v154
  v_mfma_f32_32x32x16_bf16 v[48:63], v[188:191], v[120:123], v[48:63]
  ds_read_b64_tr_b16 v[180:181], v76 offset:0
  ds_read_b64_tr_b16 v[182:183], v76 offset:1024
  v_add_f32 v94, v94, v155
  v_lshlrev_b32 v152, 16, v148
  v_and_b32 v153, 0xffff0000, v148
  v_mfma_f32_32x32x16_bf16 v[0:15], v[192:195], v[124:127], v[0:15]
  ds_read_b64_tr_b16 v[184:185], v77 offset:0
  ds_read_b64_tr_b16 v[186:187], v77 offset:1024
  v_add_f32 v95, v95, v152
  v_add_f32 v95, v95, v153
  v_lshlrev_b32 v154, 16, v149
  v_and_b32 v155, 0xffff0000, v149
  s_waitcnt lgkmcnt(14)
  v_mfma_f32_32x32x16_bf16 v[16:31], v[196:199], v[124:127], v[16:31]
  ds_read_b64_tr_b16 v[188:189], v78 offset:0
  ds_read_b64_tr_b16 v[190:191], v78 offset:1024
  s_waitcnt lgkmcnt(8)
  s_add_u32 m0, s55, 65536
  s_xor_b32 s64, s57, 640
  buffer_load_dwordx4 v65, s[4:7], s64 offen offset:0 lds
  v_add_f32 v95, v95, v154
  v_add_f32 v95, v95, v155
  v_lshlrev_b32 v152, 16, v150
  v_mfma_f32_32x32x16_bf16 v[32:47], v[200:203], v[124:127], v[32:47]
  ds_read_b64_tr_b16 v[192:193], v75 offset:8192
  ds_read_b64_tr_b16 v[194:195], v75 offset:9216
  v_and_b32 v153, 0xffff0000, v150
  v_add_f32 v95, v95, v152
  v_add_f32 v95, v95, v153
  v_lshlrev_b32 v154, 16, v151
  v_mfma_f32_32x32x16_bf16 v[48:63], v[204:207], v[124:127], v[48:63]
  ds_read_b64_tr_b16 v[196:197], v76 offset:8192
  ds_read_b64_tr_b16 v[198:199], v76 offset:9216
  s_add_u32 m0, s55, 65536
  s_xor_b32 s64, s57, 640
  buffer_load_dwordx4 v66, s[4:7], s64 offen offset:1024 lds
  v_and_b32 v155, 0xffff0000, v151
  v_add_f32 v95, v95, v154
  v_add_f32 v95, v95, v155
  s_waitcnt lgkmcnt(10)
  v_mfma_f32_32x32x16_bf16 v[0:15], v[176:179], v[128:131], v[0:15]
  ds_read_b64_tr_b16 v[200:201], v77 offset:8192
  ds_read_b64_tr_b16 v[202:203], v77 offset:9216
  ds_read_b64_tr_b16 v[144:145], v83 offset:2048
  ds_read_b64_tr_b16 v[146:147], v83 offset:3072
  ds_read_b64_tr_b16 v[148:149], v84 offset:2048
  ds_read_b64_tr_b16 v[150:151], v84 offset:3072
  s_waitcnt lgkmcnt(14)
  v_mfma_f32_32x32x16_bf16 v[16:31], v[180:183], v[128:131], v[16:31]
  ds_read_b64_tr_b16 v[204:205], v78 offset:8192
  ds_read_b64_tr_b16 v[206:207], v78 offset:9216
  s_waitcnt lgkmcnt(2)
  v_lshlrev_b32 v152, 16, v144
  v_and_b32 v153, 0xffff0000, v144
  v_add_f32 v94, v94, v152
  v_mfma_f32_32x32x16_bf16 v[32:47], v[184:187], v[128:131], v[32:47]
  ds_read_b64_tr_b16 v[176:177], v75 offset:16384
  ds_read_b64_tr_b16 v[178:179], v75 offset:17408
  s_add_u32 m0, s55, 65536
  s_xor_b32 s64, s57, 640
  buffer_load_dwordx4 v67, s[4:7], s64 offen offset:2048 lds
  v_add_f32 v94, v94, v153
  v_lshlrev_b32 v154, 16, v145
  v_mfma_f32_32x32x16_bf16 v[48:63], v[188:191], v[128:131], v[48:63]
  ds_read_b64_tr_b16 v[180:181], v76 offset:16384
  ds_read_b64_tr_b16 v[182:183], v76 offset:17408
  v_and_b32 v155, 0xffff0000, v145
  v_add_f32 v94, v94, v154
  v_mfma_f32_32x32x16_bf16 v[0:15], v[192:195], v[132:135], v[0:15]
  ds_read_b64_tr_b16 v[184:185], v77 offset:16384
  ds_read_b64_tr_b16 v[186:187], v77 offset:17408
  s_add_u32 m0, s55, 65536
  s_xor_b32 s64, s57, 640
  buffer_load_dwordx4 v68, s[4:7], s64 offen offset:3072 lds
  v_add_f32 v94, v94, v155
  v_lshlrev_b32 v152, 16, v146
  v_mfma_f32_32x32x16_bf16 v[16:31], v[196:199], v[132:135], v[16:31]
  ds_read_b64_tr_b16 v[188:189], v78 offset:16384
  ds_read_b64_tr_b16 v[190:191], v78 offset:17408
  v_and_b32 v153, 0xffff0000, v146
  v_add_f32 v94, v94, v152
  v_mfma_f32_32x32x16_bf16 v[32:47], v[200:203], v[132:135], v[32:47]
  ds_read_b64_tr_b16 v[192:193], v75 offset:24576
  ds_read_b64_tr_b16 v[194:195], v75 offset:25600
  v_add_f32 v94, v94, v153
  v_lshlrev_b32 v154, 16, v147
  s_waitcnt lgkmcnt(10)
  v_mfma_f32_32x32x16_bf16 v[48:63], v[204:207], v[132:135], v[48:63]
  ds_read_b64_tr_b16 v[196:197], v76 offset:24576
  ds_read_b64_tr_b16 v[198:199], v76 offset:25600
  v_and_b32 v155, 0xffff0000, v147
  v_add_f32 v94, v94, v154
  s_waitcnt lgkmcnt(10)
  v_mfma_f32_32x32x16_bf16 v[0:15], v[176:179], v[136:139], v[0:15]
  ds_read_b64_tr_b16 v[200:201], v77 offset:24576
  ds_read_b64_tr_b16 v[202:203], v77 offset:25600
  v_add_f32 v94, v94, v155
  v_lshlrev_b32 v152, 16, v148
  v_and_b32 v153, 0xffff0000, v148
  s_waitcnt lgkmcnt(10)
  v_mfma_f32_32x32x16_bf16 v[16:31], v[180:183], v[136:139], v[16:31]
  ds_read_b64_tr_b16 v[204:205], v78 offset:24576
  ds_read_b64_tr_b16 v[206:207], v78 offset:25600
  s_waitcnt vmcnt(5)
  ds_read_b128 v[112:115], v71 offset:0
  ds_read_b128 v[116:119], v72 offset:0
  ds_read_b128 v[120:123], v73 offset:0
  ds_read_b128 v[124:127], v74 offset:0
  v_add_f32 v95, v95, v152
  v_add_f32 v95, v95, v153
  s_waitcnt lgkmcnt(14)
  v_mfma_f32_32x32x16_bf16 v[32:47], v[184:187], v[136:139], v[32:47]
  v_lshlrev_b32 v154, 16, v149
  v_and_b32 v155, 0xffff0000, v149
  s_waitcnt lgkmcnt(12)
  v_mfma_f32_32x32x16_bf16 v[48:63], v[188:191], v[136:139], v[48:63]
  v_add_f32 v95, v95, v154
  v_add_f32 v95, v95, v155
  s_waitcnt lgkmcnt(10)
  v_mfma_f32_32x32x16_bf16 v[0:15], v[192:195], v[140:143], v[0:15]
  v_lshlrev_b32 v152, 16, v150
  v_and_b32 v153, 0xffff0000, v150
  s_waitcnt lgkmcnt(8)
  v_mfma_f32_32x32x16_bf16 v[16:31], v[196:199], v[140:143], v[16:31]
  s_waitcnt lgkmcnt(0)
  s_barrier
  ds_read_b64_tr_b16 v[176:177], v75 offset:2048
  ds_read_b64_tr_b16 v[178:179], v75 offset:3072
  ds_read_b64_tr_b16 v[180:181], v76 offset:2048
  ds_read_b64_tr_b16 v[182:183], v76 offset:3072
  ds_read_b64_tr_b16 v[184:185], v77 offset:2048
  ds_read_b64_tr_b16 v[186:187], v77 offset:3072
  ds_read_b64_tr_b16 v[188:189], v78 offset:2048
  ds_read_b64_tr_b16 v[190:191], v78 offset:3072
  s_add_u32 m0, s55, 131072
  s_xor_b32 s64, s58, 3670016
  buffer_load_dwordx4 v69, s[8:11], s64 offen offset:0 lds
  v_add_f32 v95, v95, v152
  v_add_f32 v95, v95, v153
  v_mfma_f32_32x32x16_bf16 v[32:47], v[200:203], v[140:143], v[32:47]
  ds_read_b64_tr_b16 v[192:193], v75 offset:10240
  ds_read_b64_tr_b16 v[194:195], v75 offset:11264
  s_add_u32 m0, s55, 131072
  s_xor_b32 s64, s58, 3670016
  buffer_load_dwordx4 v70, s[8:11], s64 offen offset:1024 lds
  v_lshlrev_b32 v154, 16, v151
  v_and_b32 v155, 0xffff0000, v151
  v_mfma_f32_32x32x16_bf16 v[48:63], v[204:207], v[140:143], v[48:63]
  ds_read_b64_tr_b16 v[196:197], v76 offset:10240
  ds_read_b64_tr_b16 v[198:199], v76 offset:11264
  s_add_u32 m0, s55, 32768
  s_xor_b32 s64, s57, 768
  buffer_load_dwordx4 v65, s[4:7], s64 offen offset:0 lds
  v_add_f32 v95, v95, v154
  v_add_f32 v95, v95, v155
  s_waitcnt lgkmcnt(10)
  v_mfma_f32_32x32x16_bf16 v[0:15], v[176:179], v[112:115], v[0:15]
  ds_read_b64_tr_b16 v[200:201], v77 offset:10240
  ds_read_b64_tr_b16 v[202:203], v77 offset:11264
  s_add_u32 m0, s55, 32768
  s_xor_b32 s64, s57, 768
  buffer_load_dwordx4 v66, s[4:7], s64 offen offset:1024 lds
  ds_read_b64_tr_b16 v[144:145], v85 offset:0
  ds_read_b64_tr_b16 v[146:147], v85 offset:1024
  ds_read_b64_tr_b16 v[148:149], v86 offset:0
  ds_read_b64_tr_b16 v[150:151], v86 offset:1024
  s_waitcnt lgkmcnt(14)
  v_mfma_f32_32x32x16_bf16 v[16:31], v[180:183], v[112:115], v[16:31]
  ds_read_b64_tr_b16 v[204:205], v78 offset:10240
  ds_read_b64_tr_b16 v[206:207], v78 offset:11264
  s_waitcnt lgkmcnt(2)
  v_lshlrev_b32 v152, 16, v144
  v_and_b32 v153, 0xffff0000, v144
  v_add_f32 v94, v94, v152
  v_add_f32 v94, v94, v153
  v_lshlrev_b32 v154, 16, v145
  v_and_b32 v155, 0xffff0000, v145
  v_add_f32 v94, v94, v154
  v_mfma_f32_32x32x16_bf16 v[32:47], v[184:187], v[112:115], v[32:47]
  ds_read_b64_tr_b16 v[176:177], v75 offset:18432
  ds_read_b64_tr_b16 v[178:179], v75 offset:19456
  s_add_u32 m0, s55, 32768
  s_xor_b32 s64, s57, 768
  buffer_load_dwordx4 v67, s[4:7], s64 offen offset:2048 lds
  v_add_f32 v94, v94, v155
  v_lshlrev_b32 v152, 16, v146
  v_and_b32 v153, 0xffff0000, v146
  v_add_f32 v94, v94, v152
  v_add_f32 v94, v94, v153
  v_lshlrev_b32 v154, 16, v147
  v_mfma_f32_32x32x16_bf16 v[48:63], v[188:191], v[112:115], v[48:63]
  ds_read_b64_tr_b16 v[180:181], v76 offset:18432
  ds_read_b64_tr_b16 v[182:183], v76 offset:19456
  s_add_u32 m0, s55, 32768
  s_xor_b32 s64, s57, 768
  buffer_load_dwordx4 v68, s[4:7], s64 offen offset:3072 lds
  v_and_b32 v155, 0xffff0000, v147
  v_add_f32 v94, v94, v154
  v_add_f32 v94, v94, v155
  v_lshlrev_b32 v152, 16, v148
  v_and_b32 v153, 0xffff0000, v148
  v_add_f32 v95, v95, v152
  v_add_f32 v95, v95, v153
  v_mfma_f32_32x32x16_bf16 v[0:15], v[192:195], v[116:119], v[0:15]
  ds_read_b64_tr_b16 v[184:185], v77 offset:18432
  ds_read_b64_tr_b16 v[186:187], v77 offset:19456
  s_add_u32 m0, s55, 0
  s_xor_b32 s64, s59, 0
  buffer_load_dwordx4 v251, s[12:15], s64 offen offset:0 lds
  v_lshlrev_b32 v154, 16, v149
  v_and_b32 v155, 0xffff0000, v149
  v_add_f32 v95, v95, v154
  v_add_f32 v95, v95, v155
  v_lshlrev_b32 v152, 16, v150
  v_and_b32 v153, 0xffff0000, v150
  v_mfma_f32_32x32x16_bf16 v[16:31], v[196:199], v[116:119], v[16:31]
  ds_read_b64_tr_b16 v[188:189], v78 offset:18432
  ds_read_b64_tr_b16 v[190:191], v78 offset:19456
  s_add_u32 m0, s55, 0
  s_xor_b32 s64, s59, 0
  buffer_load_dwordx4 v252, s[12:15], s64 offen offset:1024 lds
  v_add_f32 v95, v95, v152
  v_add_f32 v95, v95, v153
  v_lshlrev_b32 v154, 16, v151
  v_and_b32 v155, 0xffff0000, v151
  v_add_f32 v95, v95, v154
  v_add_f32 v95, v95, v155
  v_mfma_f32_32x32x16_bf16 v[32:47], v[200:203], v[116:119], v[32:47]
  ds_read_b64_tr_b16 v[192:193], v75 offset:26624
  ds_read_b64_tr_b16 v[194:195], v75 offset:27648
  ds_read_b64_tr_b16 v[144:145], v85 offset:2048
  ds_read_b64_tr_b16 v[146:147], v85 offset:3072
  ds_read_b64_tr_b16 v[148:149], v86 offset:2048
  ds_read_b64_tr_b16 v[150:151], v86 offset:3072
  s_waitcnt lgkmcnt(14)
  v_mfma_f32_32x32x16_bf16 v[48:63], v[204:207], v[116:119], v[48:63]
  ds_read_b64_tr_b16 v[196:197], v76 offset:26624
  ds_read_b64_tr_b16 v[198:199], v76 offset:27648
  s_waitcnt lgkmcnt(2)
  v_lshlrev_b32 v152, 16, v144
  v_and_b32 v153, 0xffff0000, v144
  v_add_f32 v94, v94, v152
  v_add_f32 v94, v94, v153
  v_mfma_f32_32x32x16_bf16 v[0:15], v[176:179], v[120:123], v[0:15]
  ds_read_b64_tr_b16 v[200:201], v77 offset:26624
  ds_read_b64_tr_b16 v[202:203], v77 offset:27648
  v_lshlrev_b32 v154, 16, v145
  v_and_b32 v155, 0xffff0000, v145
  v_add_f32 v94, v94, v154
  v_add_f32 v94, v94, v155
  v_mfma_f32_32x32x16_bf16 v[16:31], v[180:183], v[120:123], v[16:31]
  ds_read_b64_tr_b16 v[204:205], v78 offset:26624
  ds_read_b64_tr_b16 v[206:207], v78 offset:27648
  s_waitcnt vmcnt(8)
  ds_read_b128 v[128:131], v71 offset:32768
  ds_read_b128 v[132:135], v72 offset:32768
  ds_read_b128 v[136:139], v73 offset:32768
  ds_read_b128 v[140:143], v74 offset:32768
  v_lshlrev_b32 v152, 16, v146
  v_and_b32 v153, 0xffff0000, v146
  v_add_f32 v94, v94, v152
  v_mfma_f32_32x32x16_bf16 v[32:47], v[184:187], v[120:123], v[32:47]
  ds_read_b64_tr_b16 v[176:177], v224 offset:0
  ds_read_b64_tr_b16 v[178:179], v224 offset:1024
  v_add_f32 v94, v94, v153
  v_lshlrev_b32 v154, 16, v147
  v_and_b32 v155, 0xffff0000, v147
  v_add_f32 v94, v94, v154
  v_mfma_f32_32x32x16_bf16 v[48:63], v[188:191], v[120:123], v[48:63]
  ds_read_b64_tr_b16 v[180:181], v225 offset:0
  ds_read_b64_tr_b16 v[182:183], v225 offset:1024
  v_add_f32 v94, v94, v155
  v_lshlrev_b32 v152, 16, v148
  v_and_b32 v153, 0xffff0000, v148
  v_mfma_f32_32x32x16_bf16 v[0:15], v[192:195], v[124:127], v[0:15]
  ds_read_b64_tr_b16 v[184:185], v226 offset:0
  ds_read_b64_tr_b16 v[186:187], v226 offset:1024
  v_add_f32 v95, v95, v152
  v_add_f32 v95, v95, v153
  v_lshlrev_b32 v154, 16, v149
  v_and_b32 v155, 0xffff0000, v149
  s_waitcnt lgkmcnt(14)
  v_mfma_f32_32x32x16_bf16 v[16:31], v[196:199], v[124:127], v[16:31]
  ds_read_b64_tr_b16 v[188:189], v227 offset:0
  ds_read_b64_tr_b16 v[190:191], v227 offset:1024
  v_lshlrev_b32 v99, 4, v255
  s_mov_b32 s70, 16793600
  buffer_load_dword v213, v91, s[28:31], 0 offen sc1
  buffer_load_dwordx4 v[104:107], v99, s[24:27], s70 offen offset:0 sc1
  buffer_load_dwordx4 v[108:111], v99, s[24:27], s70 offen offset:1024 sc1
  s_waitcnt lgkmcnt(8)
  s_add_u32 m0, s55, 65536
  s_xor_b32 s64, s57, 896
  buffer_load_dwordx4 v65, s[4:7], s64 offen offset:0 lds
  v_add_f32 v95, v95, v154
  v_add_f32 v95, v95, v155
  v_lshlrev_b32 v152, 16, v150
  v_mfma_f32_32x32x16_bf16 v[32:47], v[200:203], v[124:127], v[32:47]
  ds_read_b64_tr_b16 v[192:193], v224 offset:8192
  ds_read_b64_tr_b16 v[194:195], v224 offset:9216
  v_and_b32 v153, 0xffff0000, v150
  v_add_f32 v95, v95, v152
  v_add_f32 v95, v95, v153
  v_lshlrev_b32 v154, 16, v151
  v_mfma_f32_32x32x16_bf16 v[48:63], v[204:207], v[124:127], v[48:63]
  ds_read_b64_tr_b16 v[196:197], v225 offset:8192
  ds_read_b64_tr_b16 v[198:199], v225 offset:9216
  s_add_u32 m0, s55, 65536
  s_xor_b32 s64, s57, 896
  buffer_load_dwordx4 v66, s[4:7], s64 offen offset:1024 lds
  v_and_b32 v155, 0xffff0000, v151
  v_add_f32 v95, v95, v154
  v_add_f32 v95, v95, v155
  s_waitcnt lgkmcnt(10)
  v_mfma_f32_32x32x16_bf16 v[0:15], v[176:179], v[128:131], v[0:15]
  ds_read_b64_tr_b16 v[200:201], v226 offset:8192
  ds_read_b64_tr_b16 v[202:203], v226 offset:9216
  s_waitcnt vmcnt(11)
  ds_read_b64_tr_b16 v[144:145], v85 offset:32768
  ds_read_b64_tr_b16 v[146:147], v85 offset:33792
  ds_read_b64_tr_b16 v[148:149], v86 offset:32768
  ds_read_b64_tr_b16 v[150:151], v86 offset:33792
  s_waitcnt lgkmcnt(14)
  v_mfma_f32_32x32x16_bf16 v[16:31], v[180:183], v[128:131], v[16:31]
  ds_read_b64_tr_b16 v[204:205], v227 offset:8192
  ds_read_b64_tr_b16 v[206:207], v227 offset:9216
  s_waitcnt lgkmcnt(2)
  v_lshlrev_b32 v152, 16, v144
  v_and_b32 v153, 0xffff0000, v144
  v_add_f32 v94, v94, v152
  v_add_f32 v94, v94, v153
  v_mfma_f32_32x32x16_bf16 v[32:47], v[184:187], v[128:131], v[32:47]
  ds_read_b64_tr_b16 v[176:177], v224 offset:16384
  ds_read_b64_tr_b16 v[178:179], v224 offset:17408
  s_add_u32 m0, s55, 65536
  s_xor_b32 s64, s57, 896
  buffer_load_dwordx4 v67, s[4:7], s64 offen offset:2048 lds
  v_lshlrev_b32 v154, 16, v145
  v_and_b32 v155, 0xffff0000, v145
  v_add_f32 v94, v94, v154
  v_add_f32 v94, v94, v155
  v_mfma_f32_32x32x16_bf16 v[48:63], v[188:191], v[128:131], v[48:63]
  ds_read_b64_tr_b16 v[180:181], v225 offset:16384
  ds_read_b64_tr_b16 v[182:183], v225 offset:17408
  v_lshlrev_b32 v152, 16, v146
  v_and_b32 v153, 0xffff0000, v146
  v_add_f32 v94, v94, v152
  v_mfma_f32_32x32x16_bf16 v[0:15], v[192:195], v[132:135], v[0:15]
  ds_read_b64_tr_b16 v[184:185], v226 offset:16384
  ds_read_b64_tr_b16 v[186:187], v226 offset:17408
  s_add_u32 m0, s55, 65536
  s_xor_b32 s64, s57, 896
  buffer_load_dwordx4 v68, s[4:7], s64 offen offset:3072 lds
  v_add_f32 v94, v94, v153
  v_lshlrev_b32 v154, 16, v147
  v_and_b32 v155, 0xffff0000, v147
  v_add_f32 v94, v94, v154
  v_mfma_f32_32x32x16_bf16 v[16:31], v[196:199], v[132:135], v[16:31]
  ds_read_b64_tr_b16 v[188:189], v227 offset:16384
  ds_read_b64_tr_b16 v[190:191], v227 offset:17408
  v_add_f32 v94, v94, v155
  v_lshlrev_b32 v152, 16, v148
  v_and_b32 v153, 0xffff0000, v148
  v_mfma_f32_32x32x16_bf16 v[32:47], v[200:203], v[132:135], v[32:47]
  ds_read_b64_tr_b16 v[192:193], v224 offset:24576
  ds_read_b64_tr_b16 v[194:195], v224 offset:25600
  v_add_f32 v95, v95, v152
  v_add_f32 v95, v95, v153
  v_lshlrev_b32 v154, 16, v149
  v_and_b32 v155, 0xffff0000, v149
  s_waitcnt lgkmcnt(10)
  v_mfma_f32_32x32x16_bf16 v[48:63], v[204:207], v[132:135], v[48:63]
  ds_read_b64_tr_b16 v[196:197], v225 offset:24576
  ds_read_b64_tr_b16 v[198:199], v225 offset:25600
  v_add_f32 v95, v95, v154
  v_add_f32 v95, v95, v155
  v_lshlrev_b32 v152, 16, v150
  s_waitcnt lgkmcnt(10)
  v_mfma_f32_32x32x16_bf16 v[0:15], v[176:179], v[136:139], v[0:15]
  ds_read_b64_tr_b16 v[200:201], v226 offset:24576
  ds_read_b64_tr_b16 v[202:203], v226 offset:25600
  v_and_b32 v153, 0xffff0000, v150
  v_add_f32 v95, v95, v152
  v_add_f32 v95, v95, v153
  v_lshlrev_b32 v154, 16, v151
  s_waitcnt lgkmcnt(10)
  v_mfma_f32_32x32x16_bf16 v[16:31], v[180:183], v[136:139], v[16:31]
  ds_read_b64_tr_b16 v[204:205], v227 offset:24576
  ds_read_b64_tr_b16 v[206:207], v227 offset:25600
  s_waitcnt vmcnt(9)
  ds_read_b128 v[112:115], v71 offset:0
  ds_read_b128 v[116:119], v72 offset:0
  ds_read_b128 v[120:123], v73 offset:0
  ds_read_b128 v[124:127], v74 offset:0
  v_and_b32 v155, 0xffff0000, v151
  v_add_f32 v95, v95, v154
  v_add_f32 v95, v95, v155
  s_waitcnt lgkmcnt(14)
  v_mfma_f32_32x32x16_bf16 v[32:47], v[184:187], v[136:139], v[32:47]
  v_lshlrev_b32 v96, 2, v255
  s_add_u32 s65, s55, 133120
  v_add_u32 v96, s65, v96
  ds_write_b32 v96, v94
  ds_write_b32 v96, v95 offset:256
  s_waitcnt lgkmcnt(14)
  v_mfma_f32_32x32x16_bf16 v[48:63], v[188:191], v[136:139], v[48:63]
  s_waitcnt lgkmcnt(12)
  v_mfma_f32_32x32x16_bf16 v[0:15], v[192:195], v[140:143], v[0:15]
  s_waitcnt lgkmcnt(10)
  v_mfma_f32_32x32x16_bf16 v[16:31], v[196:199], v[140:143], v[16:31]
  s_waitcnt vmcnt(4)
  s_waitcnt lgkmcnt(0)
  s_barrier
  s_mov_b32 s80, 0
Lspin_4:
  v_xor_b32 v90, v105, v107
  v_xor_b32 v98, v109, v111
  v_or_b32 v90, v90, v98
  v_xor_b32 v98, v105, v109
  v_or_b32 v90, v90, v98
  v_xor_b32 v98, v213, v105
  v_or_b32 v90, v90, v98
  v_not_b32 v98, v213
  v_lshrrev_b32 v98, 31, v98
  v_or_b32 v90, v90, v98
  v_cmp_eq_u32 vcc, 0, v90
  s_nop 0
  s_cmp_eq_u64 vcc, -1
  s_cbranch_scc1 Lok_5
  s_sleep 2
  buffer_load_dword v213, v91, s[28:31], 0 offen sc1
  buffer_load_dwordx4 v[104:107], v99, s[24:27], s70 offen offset:0 sc1
  buffer_load_dwordx4 v[108:111], v99, s[24:27], s70 offen offset:1024 sc1
  s_waitcnt vmcnt(0)
  s_add_u32 s80, s80, 1
  s_cmp_lt_u32 s80, 0x80000
  s_cbranch_scc1 Lspin_4
Lok_5:
  s_lshr_b32 s65, s57, 10
  s_lshl_b32 s65, s65, 3
  s_add_u32 s65, s65, 16777216
  v_and_b32 v96, 31, v255
  v_lshlrev_b32 v96, 3, v96
  buffer_load_dwordx2 v[92:93], v96, s[24:27], s65 offen sc1
  ds_read_b64_tr_b16 v[176:177], v224 offset:2048
  ds_read_b64_tr_b16 v[178:179], v224 offset:3072
  ds_read_b64_tr_b16 v[180:181], v225 offset:2048
  ds_read_b64_tr_b16 v[182:183], v225 offset:3072
  ds_read_b64_tr_b16 v[184:185], v226 offset:2048
  ds_read_b64_tr_b16 v[186:187], v226 offset:3072
  ds_read_b64_tr_b16 v[188:189], v227 offset:2048
  ds_read_b64_tr_b16 v[190:191], v227 offset:3072
  s_add_u32 m0, s55, 2048
  s_xor_b32 s64, s59, 16384
  buffer_load_dwordx4 v251, s[12:15], s64 offen offset:0 lds
  v_mfma_f32_32x32x16_bf16 v[32:47], v[200:203], v[140:143], v[32:47]
  ds_read_b64_tr_b16 v[192:193], v224 offset:10240
  ds_read_b64_tr_b16 v[194:195], v224 offset:11264
  s_add_u32 m0, s55, 2048
  s_xor_b32 s64, s59, 16384
  buffer_load_dwordx4 v252, s[12:15], s64 offen offset:1024 lds
  v_mfma_f32_32x32x16_bf16 v[48:63], v[204:207], v[140:143], v[48:63]
  ds_read_b64_tr_b16 v[196:197], v225 offset:10240
  ds_read_b64_tr_b16 v[198:199], v225 offset:11264
  s_waitcnt lgkmcnt(10)
  v_mfma_f32_32x32x16_bf16 v[0:15], v[176:179], v[112:115], v[0:15]
  ds_read_b64_tr_b16 v[200:201], v226 offset:10240
  ds_read_b64_tr_b16 v[202:203], v226 offset:11264
  s_add_u32 m0, s55, 32768
  s_xor_b32 s64, s72, 0
  buffer_load_dwordx4 v253, s[16:19], s64 offen offset:0 lds
  s_waitcnt lgkmcnt(10)
  v_mfma_f32_32x32x16_bf16 v[16:31], v[180:183], v[112:115], v[16:31]
  ds_read_b64_tr_b16 v[204:205], v227 offset:10240
  ds_read_b64_tr_b16 v[206:207], v227 offset:11264
  s_cmp_ge_u32 s52, 2
  s_cbranch_scc1 Lr_6
  v_lshlrev_b32 v96, 2, v64
  v_add_u32 v96, 133120, v96
  ds_read_b32 v144, v96 offset:0
  ds_read_b32 v145, v96 offset:4096
  ds_read_b32 v146, v96 offset:8192
  ds_read_b32 v147, v96 offset:12288
  ds_read_b32 v148, v96 offset:16384
  ds_read_b32 v149, v96 offset:20480
  ds_read_b32 v150, v96 offset:24576
  ds_read_b32 v151, v96 offset:28672
  v_lshrrev_b32 v97, 4, v64
  v_and_b32 v98, 15, v64
  v_lshlrev_b32 v98, 4, v98
  v_lshl_add_u32 v97, v97, 12, v98
  v_add_u32 v97, 133632, v97
  s_waitcnt lgkmcnt(0)
  v_add_f32 v144, v144, v145
  v_add_f32 v144, v144, v146
  v_add_f32 v144, v144, v147
  v_add_f32 v144, v144, v148
  v_add_f32 v144, v144, v149
  v_add_f32 v144, v144, v150
  v_add_f32 v144, v144, v151
  v_and_b32 v145, 0xffff0000, v144
  v_sub_f32 v146, v144, v145
  v_and_b32 v147, 0xffff0000, v146
  v_sub_f32 v146, v146, v147
  v_lshrrev_b32 v145, 16, v145
  v_or_b32 v148, v145, v147
  v_lshrrev_b32 v149, 16, v146
  v_mov_b32 v150, 0
  v_mov_b32 v151, 0
  ds_write_b128 v97, v[148:151]
Lr_6:
  s_waitcnt lgkmcnt(10)
  v_mfma_f32_32x32x16_bf16 v[32:47], v[184:187], v[112:115], v[32:47]
  ds_read_b64_tr_b16 v[176:177], v224 offset:18432
  ds_read_b64_tr_b16 v[178:179], v224 offset:19456
  s_add_u32 m0, s55, 33792
  s_xor_b32 s64, s72, 4096
  buffer_load_dwordx4 v253, s[16:19], s64 offen offset:0 lds
  s_waitcnt lgkmcnt(10)
  v_mfma_f32_32x32x16_bf16 v[48:63], v[188:191], v[112:115], v[48:63]
  ds_read_b64_tr_b16 v[180:181], v225 offset:18432
  ds_read_b64_tr_b16 v[182:183], v225 offset:19456
  s_add_u32 m0, s55, 34816
  s_xor_b32 s64, s72, 8192
  buffer_load_dwordx4 v253, s[16:19], s64 offen offset:0 lds
  v_max_u32 v104, v104, v106
  v_max_u32 v108, v108, v110
  v_max_u32 v104, v104, v108
  s_waitcnt lgkmcnt(10)
  v_mfma_f32_32x32x16_bf16 v[0:15], v[192:195], v[116:119], v[0:15]
  ds_read_b64_tr_b16 v[184:185], v226 offset:18432
  ds_read_b64_tr_b16 v[186:187], v226 offset:19456
  v_max_u32_dpp v104, v104, v104 row_ror:8 row_mask:0xf bank_mask:0xf
  s_waitcnt lgkmcnt(10)
  v_mfma_f32_32x32x16_bf16 v[16:31], v[196:199], v[116:119], v[16:31]
  ds_read_b64_tr_b16 v[188:189], v227 offset:18432
  ds_read_b64_tr_b16 v[190:191], v227 offset:19456
  s_add_u32 m0, s55, 35840
  s_xor_b32 s64, s72, 12288
  buffer_load_dwordx4 v253, s[16:19], s64 offen offset:0 lds
  v_max_u32_dpp v104, v104, v104 row_ror:4 row_mask:0xf bank_mask:0xf
  s_waitcnt lgkmcnt(10)
  v_mfma_f32_32x32x16_bf16 v[32:47], v[200:203], v[116:119], v[32:47]
  ds_read_b64_tr_b16 v[192:193], v224 offset:26624
  ds_read_b64_tr_b16 v[194:195], v224 offset:27648
  v_max_u32_dpp v104, v104, v104 row_ror:2 row_mask:0xf bank_mask:0xf
  s_waitcnt lgkmcnt(10)
  v_mfma_f32_32x32x16_bf16 v[48:63], v[204:207], v[116:119], v[48:63]
  ds_read_b64_tr_b16 v[196:197], v225 offset:26624
  ds_read_b64_tr_b16 v[198:199], v225 offset:27648
  v_max_u32_dpp v104, v104, v104 row_ror:1 row_mask:0xf bank_mask:0xf
  s_waitcnt lgkmcnt(10)
  v_mfma_f32_32x32x16_bf16 v[0:15], v[176:179], v[120:123], v[0:15]
  ds_read_b64_tr_b16 v[200:201], v226 offset:26624
  ds_read_b64_tr_b16 v[202:203], v226 offset:27648
  v_max_u32_dpp v104, v104, v104 row_bcast:15 row_mask:0xa bank_mask:0xf
  s_waitcnt lgkmcnt(10)
  v_mfma_f32_32x32x16_bf16 v[16:31], v[180:183], v[120:123], v[16:31]
  ds_read_b64_tr_b16 v[204:205], v227 offset:26624
  ds_read_b64_tr_b16 v[206:207], v227 offset:27648
  s_waitcnt vmcnt(7)
  ds_read_b128 v[128:131], v71 offset:32768
  ds_read_b128 v[132:135], v72 offset:32768
  ds_read_b128 v[136:139], v73 offset:32768
  ds_read_b128 v[140:143], v74 offset:32768
  v_max_u32_dpp v104, v104, v104 row_bcast:31 row_mask:0xc bank_mask:0xf
  s_waitcnt lgkmcnt(14)
  v_mfma_f32_32x32x16_bf16 v[32:47], v[184:187], v[120:123], v[32:47]
  s_waitcnt lgkmcnt(12)
  v_mfma_f32_32x32x16_bf16 v[48:63], v[188:191], v[120:123], v[48:63]
  v_readlane_b32 s76, v104, 63
  s_waitcnt lgkmcnt(10)
  v_mfma_f32_32x32x16_bf16 v[0:15], v[192:195], v[124:127], v[0:15]
  s_waitcnt lgkmcnt(8)
  v_mfma_f32_32x32x16_bf16 v[16:31], v[196:199], v[124:127], v[16:31]
  s_waitcnt vmcnt(6)
  s_waitcnt lgkmcnt(0)
  s_barrier
  ds_read_b64_tr_b16 v[176:177], v224 offset:32768
  ds_read_b64_tr_b16 v[178:179], v224 offset:33792
  ds_read_b64_tr_b16 v[180:181], v224 offset:40960
  ds_read_b64_tr_b16 v[182:183], v224 offset:41984
  ds_read_b64_tr_b16 v[184:185], v224 offset:49152
  ds_read_b64_tr_b16 v[186:187], v224 offset:50176
  ds_read_b64_tr_b16 v[188:189], v224 offset:57344
  ds_read_b64_tr_b16 v[190:191], v224 offset:58368
  v_mfma_f32_32x32x16_bf16 v[32:47], v[200:203], v[124:127], v[32:47]
  ds_read_b128 v[192:195], v87 offset:0
  v_mfma_f32_32x32x16_bf16 v[48:63], v[204:207], v[124:127], v[48:63]
  ds_read_b64_tr_b16 v[196:197], v225 offset:32768
  ds_read_b64_tr_b16 v[198:199], v225 offset:33792
  v_xor_b32 v96, 0x80000000, v92
  v_and_b32 v96, v88, v96
  s_waitcnt lgkmcnt(9)
  v_mfma_f32_32x32x16_bf16 v[0:15], v[176:179], v[128:131], v[0:15]
  ds_read_b64_tr_b16 v[200:201], v225 offset:40960
  ds_read_b64_tr_b16 v[202:203], v225 offset:41984
  v_lshrrev_b32 v101, 16, v96
  v_or_b32 v100, v101, v96
  s_waitcnt lgkmcnt(9)
  v_mfma_f32_32x32x16_bf16 v[0:15], v[180:183], v[132:135], v[0:15]
  ds_read_b64_tr_b16 v[204:205], v225 offset:49152
  ds_read_b64_tr_b16 v[206:207], v225 offset:50176
  v_mov_b32 v102, 0
  v_mov_b32 v103, 0
  s_waitcnt lgkmcnt(9)
  v_mfma_f32_32x32x16_bf16 v[0:15], v[184:187], v[136:139], v[0:15]
  ds_read_b64_tr_b16 v[176:177], v225 offset:57344
  ds_read_b64_tr_b16 v[178:179], v225 offset:58368
  v_mul_f32 v89, 0x3e0293ee, v93
  s_add_u32 m0, s55, 65536
  s_xor_b32 s64, s59, 32768
  buffer_load_dwordx4 v251, s[12:15], s64 offen offset:0 lds
  s_waitcnt lgkmcnt(9)
  v_mfma_f32_32x32x16_bf16 v[0:15], v[188:191], v[140:143], v[0:15]
  ds_read_b128 v[180:183], v87 offset:8192
  s_waitcnt lgkmcnt(9)
  v_mfma_f32_32x32x16_bf16 v[0:15], v[192:195], v[100:103], v[0:15]
  ds_read_b64_tr_b16 v[184:185], v226 offset:32768
  ds_read_b64_tr_b16 v[186:187], v226 offset:33792
  s_add_u32 m0, s55, 65536
  s_xor_b32 s64, s59, 32768
  buffer_load_dwordx4 v252, s[12:15], s64 offen offset:1024 lds
  s_waitcnt lgkmcnt(9)
  v_mfma_f32_32x32x16_bf16 v[16:31], v[196:199], v[128:131], v[16:31]
  ds_read_b64_tr_b16 v[188:189], v226 offset:40960
  ds_read_b64_tr_b16 v[190:191], v226 offset:41984
  s_waitcnt lgkmcnt(9)
  v_mfma_f32_32x32x16_bf16 v[16:31], v[200:203], v[132:135], v[16:31]
  ds_read_b64_tr_b16 v[192:193], v226 offset:49152
  ds_read_b64_tr_b16 v[194:195], v226 offset:50176
  s_waitcnt lgkmcnt(9)
  v_mfma_f32_32x32x16_bf16 v[16:31], v[204:207], v[136:139], v[16:31]
  ds_read_b64_tr_b16 v[196:197], v226 offset:57344
  ds_read_b64_tr_b16 v[198:199], v226 offset:58368
  v_mul_f32 v0, v0, v89
  v_mul_f32 v1, v1, v89
  v_cvt_pk_bf16_f32 v144, v0, v1
  v_mul_f32 v2, v2, v89
  v_mul_f32 v3, v3, v89
  s_add_u32 m0, s55, 67584
  s_xor_b32 s64, s59, 49152
  buffer_load_dwordx4 v251, s[12:15], s64 offen offset:0 lds
  s_waitcnt lgkmcnt(9)
  v_mfma_f32_32x32x16_bf16 v[16:31], v[176:179], v[140:143], v[16:31]
  ds_read_b128 v[200:203], v87 offset:16384
  v_cvt_pk_bf16_f32 v145, v2, v3
  v_mul_f32 v4, v4, v89
  v_mul_f32 v5, v5, v89
  v_cvt_pk_bf16_f32 v146, v4, v5
  v_mul_f32 v6, v6, v89
  s_waitcnt lgkmcnt(9)
  v_mfma_f32_32x32x16_bf16 v[16:31], v[180:183], v[100:103], v[16:31]
  ds_read_b64_tr_b16 v[204:205], v227 offset:32768
  ds_read_b64_tr_b16 v[206:207], v227 offset:33792
  v_mul_f32 v7, v7, v89
  v_cvt_pk_bf16_f32 v147, v6, v7
  v_mul_f32 v8, v8, v89
  v_mul_f32 v9, v9, v89
  v_cvt_pk_bf16_f32 v148, v8, v9
  s_waitcnt lgkmcnt(9)
  v_mfma_f32_32x32x16_bf16 v[32:47], v[184:187], v[128:131], v[32:47]
  ds_read_b64_tr_b16 v[176:177], v227 offset:40960
  ds_read_b64_tr_b16 v[178:179], v227 offset:41984
  v_mul_f32 v10, v10, v89
  v_mul_f32 v11, v11, v89
  v_cvt_pk_bf16_f32 v149, v10, v11
  v_mul_f32 v12, v12, v89
  v_mul_f32 v13, v13, v89
  s_add_u32 m0, s55, 67584
  s_xor_b32 s64, s59, 49152
  buffer_load_dwordx4 v252, s[12:15], s64 offen offset:1024 lds
  s_waitcnt lgkmcnt(9)
  v_mfma_f32_32x32x16_bf16 v[32:47], v[188:191], v[132:135], v[32:47]
  ds_read_b64_tr_b16 v[180:181], v227 offset:49152
  ds_read_b64_tr_b16 v[182:183], v227 offset:50176
  v_cvt_pk_bf16_f32 v150, v12, v13
  v_mul_f32 v14, v14, v89
  v_mul_f32 v15, v15, v89
  v_cvt_pk_bf16_f32 v151, v14, v15
  s_waitcnt lgkmcnt(9)
  v_mfma_f32_32x32x16_bf16 v[32:47], v[192:195], v[136:139], v[32:47]
  ds_read_b64_tr_b16 v[184:185], v227 offset:57344
  ds_read_b64_tr_b16 v[186:187], v227 offset:58368
  v_mul_f32 v16, v16, v89
  v_mul_f32 v17, v17, v89
  v_cvt_pk_bf16_f32 v152, v16, v17
  v_mul_f32 v18, v18, v89
  v_mul_f32 v19, v19, v89
  s_waitcnt lgkmcnt(9)
  v_mfma_f32_32x32x16_bf16 v[32:47], v[196:199], v[140:143], v[32:47]
  ds_read_b128 v[188:191], v87 offset:24576
  v_cvt_pk_bf16_f32 v153, v18, v19
  v_mul_f32 v20, v20, v89
  v_mul_f32 v21, v21, v89
  v_cvt_pk_bf16_f32 v154, v20, v21
  v_mul_f32 v22, v22, v89
  s_and_b32 s75, s76, 0x7ff
  s_sub_u32 s75, 2047, s75
  s_min_u32 s71, s73, 175
  s_and_b32 s65, s71, 7
  s_lshl_b32 s65, s65, 3
  s_add_u32 s65, s65, s52
  s_lshl_b32 s65, s65, 3
  v_lshrrev_b32 v107, 3, v255
  v_add_u32 v107, s65, v107
  v_lshlrev_b32 v107, 1, v107
  s_lshl_b32 s65, s75, 10
  buffer_load_ushort v106, v107, s[4:7], s65 offen
  s_lshl_b32 s65, s75, 3
  s_add_u32 s65, s65, 16777216
  v_mov_b32 v107, 0
  buffer_load_dwordx2 v[110:111], v107, s[24:27], s65 offen sc1
  s_lshr_b32 s65, s75, 6
  s_cmp_eq_u32 s65, s100
  s_cselect_b32 s79, 1, 0
  s_waitcnt lgkmcnt(9)
  v_mfma_f32_32x32x16_bf16 v[32:47], v[200:203], v[100:103], v[32:47]
  v_mul_f32 v23, v23, v89
  v_cvt_pk_bf16_f32 v155, v22, v23
  v_mul_f32 v24, v24, v89
  v_mul_f32 v25, v25, v89
  v_cvt_pk_bf16_f32 v156, v24, v25
  v_and_b32 v80, 31, v255
  v_lshlrev_b32 v80, 1, v80
  v_lshrrev_b32 v81, 5, v255
  v_lshl_add_u32 v80, v81, 12, v80
  s_lshl_b32 s65, s56, 14
  s_lshl_b32 s64, s52, 7
  s_add_u32 s65, s65, s64
  buffer_load_ushort v64, v80, s[20:23], s65 offen offset:0
  buffer_load_ushort v65, v80, s[20:23], s65 offen offset:1024
  buffer_load_ushort v66, v80, s[20:23], s65 offen offset:2048
  buffer_load_ushort v67, v80, s[20:23], s65 offen offset:3072
  s_waitcnt lgkmcnt(7)
  v_mfma_f32_32x32x16_bf16 v[48:63], v[204:207], v[128:131], v[48:63]
  v_mul_f32 v26, v26, v89
  v_mul_f32 v27, v27, v89
  v_cvt_pk_bf16_f32 v157, v26, v27
  v_mul_f32 v28, v28, v89
  v_mul_f32 v29, v29, v89
  s_waitcnt lgkmcnt(5)
  v_mfma_f32_32x32x16_bf16 v[48:63], v[176:179], v[132:135], v[48:63]
  v_cvt_pk_bf16_f32 v158, v28, v29
  v_mul_f32 v30, v30, v89
  v_mul_f32 v31, v31, v89
  v_cvt_pk_bf16_f32 v159, v30, v31
  s_waitcnt lgkmcnt(3)
  v_mfma_f32_32x32x16_bf16 v[48:63], v[180:183], v[136:139], v[48:63]
  s_waitcnt vmcnt(10)
  s_waitcnt lgkmcnt(0)
  s_barrier
  ds_read_b128 v[192:195], v232 offset:0
  ds_read_b128 v[196:199], v233 offset:0
  v_mul_f32 v32, v32, v89
  v_mul_f32 v33, v33, v89
  v_cvt_pk_bf16_f32 v160, v32, v33
  v_mul_f32 v34, v34, v89
  v_mul_f32 v35, v35, v89
  s_lshl_b32 s65, s56, 14
  s_lshl_b32 s64, s52, 7
  s_add_u32 s65, s65, s64
  s_add_u32 s65, s65, 8192
  buffer_load_ushort v68, v80, s[20:23], s65 offen offset:0
  buffer_load_ushort v69, v80, s[20:23], s65 offen offset:1024
  buffer_load_ushort v70, v80, s[20:23], s65 offen offset:2048
  buffer_load_ushort v71, v80, s[20:23], s65 offen offset:3072
  v_mfma_f32_32x32x16_bf16 v[48:63], v[184:187], v[140:143], v[48:63]
  ds_read_b128 v[176:179], v234 offset:0
  v_cvt_pk_bf16_f32 v161, v34, v35
  v_mul_f32 v36, v36, v89
  v_mul_f32 v37, v37, v89
  v_cvt_pk_bf16_f32 v162, v36, v37
  v_mul_f32 v38, v38, v89
  v_mfma_f32_32x32x16_bf16 v[48:63], v[188:191], v[100:103], v[48:63]
  ds_read_b128 v[180:183], v235 offset:0
  v_mul_f32 v39, v39, v89
  v_cvt_pk_bf16_f32 v163, v38, v39
  v_mul_f32 v40, v40, v89
  v_mul_f32 v41, v41, v89
  v_cvt_pk_bf16_f32 v164, v40, v41
  s_waitcnt lgkmcnt(3)
  v_mfma_f32_32x32x16_bf16 v[112:127], v[192:195], v[144:147], 0
  ds_read_b128 v[184:187], v236 offset:0
  v_mul_f32 v42, v42, v89
  v_mul_f32 v43, v43, v89
  v_cvt_pk_bf16_f32 v165, v42, v43
  v_mul_f32 v44, v44, v89
  v_mul_f32 v45, v45, v89
  s_lshl_b32 s65, s56, 14
  s_lshl_b32 s64, s52, 7
  s_add_u32 s65, s65, s64
  buffer_load_ushort v72, v80, s[20:23], s65 offen offset:64
  buffer_load_ushort v73, v80, s[20:23], s65 offen offset:1088
  buffer_load_ushort v74, v80, s[20:23], s65 offen offset:2112
  buffer_load_ushort v75, v80, s[20:23], s65 offen offset:3136
  s_waitcnt lgkmcnt(3)
  v_mfma_f32_32x32x16_bf16 v[112:127], v[196:199], v[148:151], v[112:127]
  ds_read_b128 v[188:191], v237 offset:0
  v_cvt_pk_bf16_f32 v166, v44, v45
  v_mul_f32 v46, v46, v89
  v_mul_f32 v47, v47, v89
  v_cvt_pk_bf16_f32 v167, v46, v47
  s_waitcnt lgkmcnt(3)
  v_mfma_f32_32x32x16_bf16 v[112:127], v[176:179], v[152:155], v[112:127]
  ds_read_b128 v[192:195], v238 offset:0
  v_mul_f32 v48, v48, v89
  v_mul_f32 v49, v49, v89
  v_cvt_pk_bf16_f32 v168, v48, v49
  v_mul_f32 v50, v50, v89
  v_mul_f32 v51, v51, v89
  v_cvt_pk_bf16_f32 v169, v50, v51
  s_waitcnt lgkmcnt(3)
  v_mfma_f32_32x32x16_bf16 v[112:127], v[180:183], v[156:159], v[112:127]
  ds_read_b128 v[196:199], v239 offset:0
  v_mul_f32 v52, v52, v89
  v_mul_f32 v53, v53, v89
  v_cvt_pk_bf16_f32 v170, v52, v53
  v_mul_f32 v54, v54, v89
  v_mul_f32 v55, v55, v89
  v_cvt_pk_bf16_f32 v171, v54, v55
  s_lshl_b32 s65, s56, 14
  s_lshl_b32 s64, s52, 7
  s_add_u32 s65, s65, s64
  s_add_u32 s65, s65, 8192
  buffer_load_ushort v76, v80, s[20:23], s65 offen offset:64
  buffer_load_ushort v77, v80, s[20:23], s65 offen offset:1088
  buffer_load_ushort v78, v80, s[20:23], s65 offen offset:2112
  buffer_load_ushort v79, v80, s[20:23], s65 offen offset:3136
  s_waitcnt lgkmcnt(3)
  v_mfma_f32_32x32x16_bf16 v[112:127], v[184:187], v[160:163], v[112:127]
  ds_read_b128 v[176:179], v232 offset:16384
  v_mul_f32 v56, v56, v89
  v_mul_f32 v57, v57, v89
  v_cvt_pk_bf16_f32 v172, v56, v57
  v_mul_f32 v58, v58, v89
  v_mul_f32 v59, v59, v89
  v_cvt_pk_bf16_f32 v173, v58, v59
  s_waitcnt lgkmcnt(3)
  v_mfma_f32_32x32x16_bf16 v[112:127], v[188:191], v[164:167], v[112:127]
  ds_read_b128 v[180:183], v233 offset:16384
  v_mul_f32 v60, v60, v89
  v_mul_f32 v61, v61, v89
  v_cvt_pk_bf16_f32 v174, v60, v61
  v_mul_f32 v62, v62, v89
  v_mul_f32 v63, v63, v89
  v_cvt_pk_bf16_f32 v175, v62, v63
  s_waitcnt lgkmcnt(3)
  v_mfma_f32_32x32x16_bf16 v[112:127], v[192:195], v[168:171], v[112:127]
  ds_read_b128 v[184:187], v234 offset:16384
  v_mov_b32 v249, 0
  v_mov_b32 v250, 0
  s_waitcnt lgkmcnt(3)
  v_mfma_f32_32x32x16_bf16 v[112:127], v[196:199], v[172:175], v[112:127]
  ds_read_b128 v[188:191], v235 offset:16384
  s_waitcnt lgkmcnt(3)
  s_nop 9
  v_max3_f32 v96, v112, v113, v114
  v_max3_f32 v97, v115, v116, v117
  v_max3_f32 v96, v96, v118, v119
  v_max3_f32 v97, v97, v120, v121
  v_max3_f32 v96, v96, v122, v123
  v_max3_f32 v97, v97, v124, v125
  v_max3_f32 v96, v96, v126, v127
  v_max_f32 v96, v96, v97
  v_mov_b32 v97, v96
  s_nop 1
  v_permlane32_swap_b32 v96, v97
  v_max_f32 v96, v96, v97
  v_sub_f32 v200, 0, v96
  v_sub_f32 v201, 0, v96
  v_sub_f32 v202, 0, v96
  v_sub_f32 v203, 0, v96
  v_sub_f32 v204, 0, v96
  v_sub_f32 v205, 0, v96
  v_sub_f32 v206, 0, v96
  v_sub_f32 v207, 0, v96
  v_sub_f32 v208, 0, v96
  v_sub_f32 v209, 0, v96
  v_sub_f32 v210, 0, v96
  v_sub_f32 v211, 0, v96
  v_sub_f32 v212, 0, v96
  v_sub_f32 v213, 0, v96
  v_sub_f32 v214, 0, v96
  v_sub_f32 v215, 0, v96
  s_nop 1
  v_mfma_f32_32x32x16_bf16 v[128:143], v[176:179], v[144:147], v[200:215]
  ds_read_b128 v[192:195], v236 offset:16384
  v_add_f32 v112, v112, v200
  v_add_f32 v113, v113, v200
  v_add_f32 v114, v114, v200
  v_add_f32 v115, v115, v200
  v_add_f32 v116, v116, v200
  v_add_f32 v117, v117, v200
  v_add_f32 v118, v118, v200
  s_waitcnt lgkmcnt(3)
  v_mfma_f32_32x32x16_bf16 v[128:143], v[180:183], v[148:151], v[128:143]
  ds_read_b128 v[196:199], v237 offset:16384
  v_add_f32 v119, v119, v200
  v_add_f32 v120, v120, v200
  v_add_f32 v121, v121, v200
  v_add_f32 v122, v122, v200
  v_add_f32 v123, v123, v200
  v_add_f32 v124, v124, v200
  v_add_f32 v125, v125, v200
  s_waitcnt lgkmcnt(3)
  v_mfma_f32_32x32x16_bf16 v[128:143], v[184:187], v[152:155], v[128:143]
  ds_read_b128 v[176:179], v238 offset:16384
  v_add_f32 v126, v126, v200
  v_add_f32 v127, v127, v200
  v_exp_f32 v112, v112
  v_exp_f32 v113, v113
  v_exp_f32 v114, v114
  v_exp_f32 v115, v115
  v_add_f32 v249, v249, v112
  s_add_u32 m0, s55, 98304
  s_xor_b32 s64, s59, 65536
  buffer_load_dwordx4 v251, s[12:15], s64 offen offset:0 lds
  s_waitcnt lgkmcnt(3)
  v_mfma_f32_32x32x16_bf16 v[128:143], v[188:191], v[156:159], v[128:143]
  ds_read_b128 v[180:183], v239 offset:16384
  v_add_f32 v250, v250, v113
  v_cvt_pk_bf16_f32 v0, v112, v113
  v_exp_f32 v116, v116
  v_exp_f32 v117, v117
  v_add_f32 v249, v249, v114
  v_add_f32 v250, v250, v115
  v_cvt_pk_bf16_f32 v1, v114, v115
  s_waitcnt lgkmcnt(3)
  v_mfma_f32_32x32x16_bf16 v[128:143], v[192:195], v[160:163], v[128:143]
  ds_read_b128 v[184:187], v232 offset:2048
  v_exp_f32 v118, v118
  v_exp_f32 v119, v119
  v_add_f32 v249, v249, v116
  v_add_f32 v250, v250, v117
  v_cvt_pk_bf16_f32 v2, v116, v117
  v_exp_f32 v120, v120
  v_exp_f32 v121, v121
  s_waitcnt lgkmcnt(3)
  v_mfma_f32_32x32x16_bf16 v[128:143], v[196:199], v[164:167], v[128:143]
  ds_read_b128 v[188:191], v233 offset:2048
  v_add_f32 v249, v249, v118
  v_add_f32 v250, v250, v119
  v_cvt_pk_bf16_f32 v3, v118, v119
  v_exp_f32 v122, v122
  v_exp_f32 v123, v123
  v_add_f32 v249, v249, v120
  v_add_f32 v250, v250, v121
  s_add_u32 m0, s55, 98304
  s_xor_b32 s64, s59, 65536
  buffer_load_dwordx4 v252, s[12:15], s64 offen offset:1024 lds
  s_waitcnt lgkmcnt(3)
  v_mfma_f32_32x32x16_bf16 v[128:143], v[176:179], v[168:171], v[128:143]
  ds_read_b128 v[192:195], v234 offset:2048
  v_cvt_pk_bf16_f32 v4, v120, v121
  v_exp_f32 v124, v124
  v_exp_f32 v125, v125
  v_add_f32 v249, v249, v122
  v_add_f32 v250, v250, v123
  v_cvt_pk_bf16_f32 v5, v122, v123
  v_exp_f32 v126, v126
  s_waitcnt lgkmcnt(3)
  v_mfma_f32_32x32x16_bf16 v[128:143], v[180:183], v[172:175], v[128:143]
  ds_read_b128 v[196:199], v235 offset:2048
  v_exp_f32 v127, v127
  v_add_f32 v249, v249, v124
  v_add_f32 v250, v250, v125
  v_cvt_pk_bf16_f32 v6, v124, v125
  v_add_f32 v249, v249, v126
  v_add_f32 v250, v250, v127
  v_cvt_pk_bf16_f32 v7, v126, v127
  s_waitcnt lgkmcnt(3)
  v_mfma_f32_32x32x16_bf16 v[112:127], v[184:187], v[144:147], v[200:215]
  ds_read_b128 v[176:179], v236 offset:2048
  s_waitcnt lgkmcnt(3)
  v_mfma_f32_32x32x16_bf16 v[112:127], v[188:191], v[148:151], v[112:127]
  ds_read_b128 v[180:183], v237 offset:2048
  s_add_u32 m0, s55, 100352
  s_xor_b32 s64, s59, 81920
  buffer_load_dwordx4 v251, s[12:15], s64 offen offset:0 lds
  s_waitcnt lgkmcnt(3)
  v_mfma_f32_32x32x16_bf16 v[112:127], v[192:195], v[152:155], v[112:127]
  ds_read_b128 v[184:187], v238 offset:2048
  v_exp_f32 v128, v128
  v_exp_f32 v129, v129
  v_exp_f32 v130, v130
  v_exp_f32 v131, v131
  v_add_f32 v249, v249, v128
  s_waitcnt lgkmcnt(3)
  v_mfma_f32_32x32x16_bf16 v[112:127], v[196:199], v[156:159], v[112:127]
  ds_read_b128 v[188:191], v239 offset:2048
  v_add_f32 v250, v250, v129
  v_cvt_pk_bf16_f32 v8, v128, v129
  v_exp_f32 v132, v132
  v_exp_f32 v133, v133
  v_add_f32 v249, v249, v130
  s_waitcnt lgkmcnt(3)
  v_mfma_f32_32x32x16_bf16 v[112:127], v[176:179], v[160:163], v[112:127]
  ds_read_b64_tr_b16 v[192:193], v248 offset:32768
  ds_read_b64_tr_b16 v[194:195], v248 offset:33280
  v_add_f32 v250, v250, v131
  v_cvt_pk_bf16_f32 v9, v130, v131
  v_exp_f32 v134, v134
  v_exp_f32 v135, v135
  v_add_f32 v249, v249, v132
  s_waitcnt lgkmcnt(4)
  v_mfma_f32_32x32x16_bf16 v[112:127], v[180:183], v[164:167], v[112:127]
  ds_read_b64_tr_b16 v[196:197], v248 offset:33792
  ds_read_b64_tr_b16 v[198:199], v248 offset:34304
  v_add_f32 v250, v250, v133
  v_cvt_pk_bf16_f32 v10, v132, v133
  v_exp_f32 v136, v136
  v_exp_f32 v137, v137
  v_add_f32 v249, v249, v134
  s_add_u32 m0, s55, 100352
  s_xor_b32 s64, s59, 81920
  buffer_load_dwordx4 v252, s[12:15], s64 offen offset:1024 lds
  s_waitcnt lgkmcnt(5)
  v_mfma_f32_32x32x16_bf16 v[112:127], v[184:187], v[168:171], v[112:127]
  ds_read_b128 v[176:179], v232 offset:18432
  v_add_f32 v250, v250, v135
  v_cvt_pk_bf16_f32 v11, v134, v135
  v_exp_f32 v138, v138
  v_exp_f32 v139, v139
  v_add_f32 v249, v249, v136
  s_waitcnt lgkmcnt(5)
  v_mfma_f32_32x32x16_bf16 v[112:127], v[188:191], v[172:175], v[112:127]
  ds_read_b128 v[180:183], v233 offset:18432
  v_add_f32 v250, v250, v137
  v_cvt_pk_bf16_f32 v12, v136, v137
  v_exp_f32 v140, v140
  v_exp_f32 v141, v141
  v_add_f32 v249, v249, v138
  s_waitcnt lgkmcnt(4)
  v_mfma_f32_32x32x16_bf16 v[216:231], v[192:195], v[0:3], 0
  ds_read_b128 v[184:187], v234 offset:18432
  v_add_f32 v250, v250, v139
  v_cvt_pk_bf16_f32 v13, v138, v139
  v_exp_f32 v142, v142
  v_exp_f32 v143, v143
  v_add_f32 v249, v249, v140
  s_waitcnt lgkmcnt(3)
  v_mfma_f32_32x32x16_bf16 v[216:231], v[196:199], v[4:7], v[216:231]
  ds_read_b128 v[188:191], v235 offset:18432
  v_add_f32 v250, v250, v141
  v_cvt_pk_bf16_f32 v14, v140, v141
  v_add_f32 v249, v249, v142
  v_add_f32 v250, v250, v143
  v_cvt_pk_bf16_f32 v15, v142, v143
  s_waitcnt lgkmcnt(3)
  v_mfma_f32_32x32x16_bf16 v[128:143], v[176:179], v[144:147], v[200:215]
  ds_read_b128 v[192:195], v236 offset:18432
  v_exp_f32 v112, v112
  v_exp_f32 v113, v113
  v_exp_f32 v114, v114
  v_exp_f32 v115, v115
  s_waitcnt vmcnt(20)
  s_waitcnt lgkmcnt(3)
  v_mfma_f32_32x32x16_bf16 v[128:143], v[180:183], v[148:151], v[128:143]
  ds_read_b128 v[196:199], v237 offset:18432
  v_add_f32 v249, v249, v112
  v_add_f32 v250, v250, v113
  v_cvt_pk_bf16_f32 v16, v112, v113
  v_exp_f32 v116, v116
  v_lshlrev_b32 v254, 16, v106
  s_waitcnt lgkmcnt(3)
  v_mfma_f32_32x32x16_bf16 v[128:143], v[184:187], v[152:155], v[128:143]
  ds_read_b128 v[176:179], v238 offset:18432
  v_exp_f32 v117, v117
  v_add_f32 v249, v249, v114
  v_add_f32 v250, v250, v115
  v_cvt_pk_bf16_f32 v17, v114, v115
  v_sub_f32 v254, v254, v110
  s_waitcnt vmcnt(4)
  v_lshl_or_b32 v240, v65, 16, v64
  s_waitcnt lgkmcnt(3)
  v_mfma_f32_32x32x16_bf16 v[128:143], v[188:191], v[156:159], v[128:143]
  ds_read_b128 v[180:183], v239 offset:18432
  v_exp_f32 v118, v118
  v_exp_f32 v119, v119
  v_add_f32 v249, v249, v116
  v_add_f32 v250, v250, v117
  v_cvt_pk_bf16_f32 v254, v254, v254
  v_lshl_or_b32 v241, v67, 16, v66
  s_waitcnt lgkmcnt(3)
  v_mfma_f32_32x32x16_bf16 v[128:143], v[192:195], v[160:163], v[128:143]
  ds_read_b64_tr_b16 v[184:185], v248 offset:34816
  ds_read_b64_tr_b16 v[186:187], v248 offset:35328
  v_cvt_pk_bf16_f32 v18, v116, v117
  v_exp_f32 v120, v120
  v_exp_f32 v121, v121
  v_add_f32 v249, v249, v118
  v_and_b32 v254, 0xffff0000, v254
  v_lshl_or_b32 v242, v69, 16, v68
  v_lshl_or_b32 v243, v71, 16, v70
  s_waitcnt lgkmcnt(4)
  v_mfma_f32_32x32x16_bf16 v[128:143], v[196:199], v[164:167], v[128:143]
  ds_read_b64_tr_b16 v[188:189], v248 offset:35840
  ds_read_b64_tr_b16 v[190:191], v248 offset:36352
  v_add_f32 v250, v250, v119
  v_cvt_pk_bf16_f32 v19, v118, v119
  v_exp_f32 v122, v122
  v_exp_f32 v123, v123
  v_mul_f32 v254, v254, v111
  v_lshl_or_b32 v244, v73, 16, v72
  s_waitcnt lgkmcnt(5)
  v_mfma_f32_32x32x16_bf16 v[128:143], v[176:179], v[168:171], v[128:143]
  v_add_f32 v249, v249, v120
  v_add_f32 v250, v250, v121
  v_cvt_pk_bf16_f32 v20, v120, v121
  v_exp_f32 v124, v124
  v_cvt_pk_bf16_f32 v254, v254, v254
  v_lshl_or_b32 v245, v75, 16, v74
  v_lshl_or_b32 v246, v77, 16, v76
  s_waitcnt lgkmcnt(4)
  v_mfma_f32_32x32x16_bf16 v[128:143], v[180:183], v[172:175], v[128:143]
  v_add_u32 v232, 65536, v232
  v_add_u32 v233, 65536, v233
  v_add_u32 v234, 65536, v234
  v_add_u32 v235, 65536, v235
  v_add_u32 v236, 65536, v236
  v_add_u32 v237, 65536, v237
  v_add_u32 v238, 65536, v238
  v_add_u32 v239, 65536, v239
  s_waitcnt lgkmcnt(0)
  s_barrier
  ds_read_b128 v[192:195], v232 offset:0
  ds_read_b128 v[196:199], v233 offset:0
  v_exp_f32 v125, v125
  v_add_f32 v249, v249, v122
  v_add_f32 v250, v250, v123
  v_cvt_pk_bf16_f32 v21, v122, v123
  v_and_b32 v254, 0xffff0000, v254
  v_lshl_or_b32 v247, v79, 16, v78
  v_mfma_f32_32x32x16_bf16 v[216:231], v[184:187], v[8:11], v[216:231]
  ds_read_b128 v[176:179], v234 offset:0
  v_exp_f32 v126, v126
  v_exp_f32 v127, v127
  v_add_f32 v249, v249, v124
  v_add_f32 v250, v250, v125
  v_mfma_f32_32x32x16_bf16 v[216:231], v[188:191], v[12:15], v[216:231]
  ds_read_b128 v[180:183], v235 offset:0
  v_cvt_pk_bf16_f32 v22, v124, v125
  v_add_f32 v249, v249, v126
  v_add_f32 v250, v250, v127
  v_cvt_pk_bf16_f32 v23, v126, v127
  s_waitcnt lgkmcnt(3)
  v_mfma_f32_32x32x16_bf16 v[112:127], v[192:195], v[144:147], v[200:215]
  ds_read_b128 v[184:187], v236 offset:0
  v_exp_f32 v128, v128
  v_exp_f32 v129, v129
  v_exp_f32 v130, v130
  v_exp_f32 v131, v131
  s_waitcnt lgkmcnt(3)
  v_mfma_f32_32x32x16_bf16 v[112:127], v[196:199], v[148:151], v[112:127]
  ds_read_b128 v[188:191], v237 offset:0
  v_add_f32 v249, v249, v128
  v_add_f32 v250, v250, v129
  v_cvt_pk_bf16_f32 v24, v128, v129
  v_exp_f32 v132, v132
  s_add_u32 m0, s55, 0
  s_xor_b32 s64, s72, 64
  buffer_load_dwordx4 v253, s[16:19], s64 offen offset:0 lds
  s_waitcnt lgkmcnt(3)
  v_mfma_f32_32x32x16_bf16 v[112:127], v[176:179], v[152:155], v[112:127]
  ds_read_b128 v[192:195], v238 offset:0
  v_exp_f32 v133, v133
  v_add_f32 v249, v249, v130
  v_add_f32 v250, v250, v131
  v_cvt_pk_bf16_f32 v25, v130, v131
  s_waitcnt lgkmcnt(3)
  v_mfma_f32_32x32x16_bf16 v[112:127], v[180:183], v[156:159], v[112:127]
  ds_read_b128 v[196:199], v239 offset:0
  v_exp_f32 v134, v134
  v_exp_f32 v135, v135
  v_add_f32 v249, v249, v132
  v_add_f32 v250, v250, v133
  s_bfe_u32 s65, s56, 0x20001
  s_lshl_b32 s65, s65, 3
  s_bfe_u32 s64, s56, 0x20003
  s_lshl_b32 s64, s64, 1
  s_or_b32 s65, s65, s64
  s_and_b32 s64, s56, 1
  s_or_b32 s65, s65, s64
  s_lshr_b32 s64, s56, 5
  s_lshl_b32 s66, s52, 3
  s_add_u32 s64, s64, s66
  s_bfm_b32 s66, s65, 0
  s_and_b32 s66, s66, 0xa4924920
  s_bcnt1_i32_b32 s66, s66
  s_lshl_b32 s67, s64, 4
  s_add_u32 s66, s66, s67
  s_add_u32 s66, s66, 2048
  s_lshl_b32 s64, s64, 5
  s_add_u32 s64, s64, s65
  s_mov_b32 s67, 0xa4924920
  s_bitcmp1_b32 s67, s65
  s_cselect_b32 s65, s66, s64
  s_lshl_b32 s65, s65, 11
  s_add_u32 s65, s65, 20971520
  s_sub_u32 s57, s60, 20971520
  s_lshr_b32 s57, s57, 1
  s_add_u32 s57, s57, 25165824
  v_lshlrev_b32 v109, 4, v255
  buffer_store_dwordx4 v[240:243], v109, s[24:27], s65 offen offset:0 sc1
  buffer_store_dwordx4 v[244:247], v109, s[24:27], s65 offen offset:1024 sc1
  s_waitcnt lgkmcnt(3)
  v_mfma_f32_32x32x16_bf16 v[112:127], v[184:187], v[160:163], v[112:127]
  ds_read_b64_tr_b16 v[176:177], v248 offset:36864
  ds_read_b64_tr_b16 v[178:179], v248 offset:37376
  v_cvt_pk_bf16_f32 v26, v132, v133
  v_exp_f32 v136, v136
  v_exp_f32 v137, v137
  v_add_f32 v249, v249, v134
  s_waitcnt lgkmcnt(4)
  v_mfma_f32_32x32x16_bf16 v[112:127], v[188:191], v[164:167], v[112:127]
  ds_read_b64_tr_b16 v[180:181], v248 offset:37888
  ds_read_b64_tr_b16 v[182:183], v248 offset:38400
  v_add_f32 v250, v250, v135
  v_cvt_pk_bf16_f32 v27, v134, v135
  v_exp_f32 v138, v138
  v_exp_f32 v139, v139
  s_waitcnt lgkmcnt(5)
  v_mfma_f32_32x32x16_bf16 v[112:127], v[192:195], v[168:171], v[112:127]
  ds_read_b128 v[184:187], v232 offset:16384
  v_add_f32 v249, v249, v136
  v_add_f32 v250, v250, v137
  v_cvt_pk_bf16_f32 v28, v136, v137
  v_exp_f32 v140, v140
  s_add_u32 m0, s55, 1024
  s_xor_b32 s64, s72, 4160
  buffer_load_dwordx4 v253, s[16:19], s64 offen offset:0 lds
  s_waitcnt lgkmcnt(5)
  v_mfma_f32_32x32x16_bf16 v[112:127], v[196:199], v[172:175], v[112:127]
  ds_read_b128 v[188:191], v233 offset:16384
  v_exp_f32 v141, v141
  v_add_f32 v249, v249, v138
  v_add_f32 v250, v250, v139
  v_cvt_pk_bf16_f32 v29, v138, v139
  s_waitcnt lgkmcnt(4)
  v_mfma_f32_32x32x16_bf16 v[216:231], v[176:179], v[16:19], v[216:231]
  ds_read_b128 v[192:195], v234 offset:16384
  v_exp_f32 v142, v142
  v_exp_f32 v143, v143
  v_add_f32 v249, v249, v140
  v_add_f32 v250, v250, v141
  s_waitcnt lgkmcnt(3)
  v_mfma_f32_32x32x16_bf16 v[216:231], v[180:183], v[20:23], v[216:231]
  ds_read_b128 v[196:199], v235 offset:16384
  v_cvt_pk_bf16_f32 v30, v140, v141
  v_add_f32 v249, v249, v142
  v_add_f32 v250, v250, v143
  v_cvt_pk_bf16_f32 v31, v142, v143
  s_waitcnt lgkmcnt(3)
  v_mfma_f32_32x32x16_bf16 v[128:143], v[184:187], v[144:147], v[200:215]
  ds_read_b128 v[176:179], v236 offset:16384
  v_exp_f32 v112, v112
  v_exp_f32 v113, v113
  v_exp_f32 v114, v114
  v_exp_f32 v115, v115
  s_waitcnt lgkmcnt(3)
  v_mfma_f32_32x32x16_bf16 v[128:143], v[188:191], v[148:151], v[128:143]
  ds_read_b128 v[180:183], v237 offset:16384
  v_add_f32 v249, v249, v112
  v_add_f32 v250, v250, v113
  v_cvt_pk_bf16_f32 v32, v112, v113
  v_exp_f32 v116, v116
  s_waitcnt lgkmcnt(3)
  v_mfma_f32_32x32x16_bf16 v[128:143], v[192:195], v[152:155], v[128:143]
  ds_read_b128 v[184:187], v238 offset:16384
  v_exp_f32 v117, v117
  v_add_f32 v249, v249, v114
  v_add_f32 v250, v250, v115
  v_cvt_pk_bf16_f32 v33, v114, v115
  s_add_u32 m0, s55, 2048
  s_xor_b32 s64, s72, 8256
  buffer_load_dwordx4 v253, s[16:19], s64 offen offset:0 lds
  s_waitcnt lgkmcnt(3)
  v_mfma_f32_32x32x16_bf16 v[128:143], v[196:199], v[156:159], v[128:143]
  ds_read_b128 v[188:191], v239 offset:16384
  v_exp_f32 v118, v118
  v_exp_f32 v119, v119
  v_add_f32 v249, v249, v116
  v_add_f32 v250, v250, v117
  s_waitcnt lgkmcnt(3)
  v_mfma_f32_32x32x16_bf16 v[128:143], v[176:179], v[160:163], v[128:143]
  ds_read_b64_tr_b16 v[192:193], v248 offset:38912
  ds_read_b64_tr_b16 v[194:195], v248 offset:39424
  v_cvt_pk_bf16_f32 v34, v116, v117
  v_exp_f32 v120, v120
  v_exp_f32 v121, v121
  v_add_f32 v249, v249, v118
  s_waitcnt lgkmcnt(4)
  v_mfma_f32_32x32x16_bf16 v[128:143], v[180:183], v[164:167], v[128:143]
  ds_read_b64_tr_b16 v[196:197], v248 offset:39936
  ds_read_b64_tr_b16 v[198:199], v248 offset:40448
  v_add_f32 v250, v250, v119
  v_cvt_pk_bf16_f32 v35, v118, v119
  v_exp_f32 v122, v122
  v_exp_f32 v123, v123
  s_waitcnt lgkmcnt(5)
  v_mfma_f32_32x32x16_bf16 v[128:143], v[184:187], v[168:171], v[128:143]
  ds_read_b128 v[176:179], v232 offset:2048
  v_add_f32 v249, v249, v120
  v_add_f32 v250, v250, v121
  v_cvt_pk_bf16_f32 v36, v120, v121
  v_exp_f32 v124, v124
  s_waitcnt lgkmcnt(5)
  v_mfma_f32_32x32x16_bf16 v[128:143], v[188:191], v[172:175], v[128:143]
  ds_read_b128 v[180:183], v233 offset:2048
  v_exp_f32 v125, v125
  v_add_f32 v249, v249, v122
  v_add_f32 v250, v250, v123
  v_cvt_pk_bf16_f32 v37, v122, v123
  s_waitcnt lgkmcnt(4)
  v_mfma_f32_32x32x16_bf16 v[216:231], v[192:195], v[24:27], v[216:231]
  ds_read_b128 v[184:187], v234 offset:2048
  v_exp_f32 v126, v126
  v_exp_f32 v127, v127
  v_add_f32 v249, v249, v124
  v_add_f32 v250, v250, v125
  s_add_u32 m0, s55, 3072
  s_xor_b32 s64, s72, 12352
  buffer_load_dwordx4 v253, s[16:19], s64 offen offset:0 lds
  s_waitcnt lgkmcnt(3)
  v_mfma_f32_32x32x16_bf16 v[216:231], v[196:199], v[28:31], v[216:231]
  ds_read_b128 v[188:191], v235 offset:2048
  v_cvt_pk_bf16_f32 v38, v124, v125
  v_add_f32 v249, v249, v126
  v_add_f32 v250, v250, v127
  v_cvt_pk_bf16_f32 v39, v126, v127
  s_waitcnt lgkmcnt(3)
  v_mfma_f32_32x32x16_bf16 v[112:127], v[176:179], v[144:147], v[200:215]
  ds_read_b128 v[192:195], v236 offset:2048
  v_exp_f32 v128, v128
  v_exp_f32 v129, v129
  v_exp_f32 v130, v130
  v_exp_f32 v131, v131
  s_waitcnt lgkmcnt(3)
  v_mfma_f32_32x32x16_bf16 v[112:127], v[180:183], v[148:151], v[112:127]
  ds_read_b128 v[196:199], v237 offset:2048
  v_add_f32 v249, v249, v128
  v_add_f32 v250, v250, v129
  v_cvt_pk_bf16_f32 v40, v128, v129
  v_exp_f32 v132, v132
  s_waitcnt lgkmcnt(3)
  v_mfma_f32_32x32x16_bf16 v[112:127], v[184:187], v[152:155], v[112:127]
  ds_read_b128 v[176:179], v238 offset:2048
  v_exp_f32 v133, v133
  v_add_f32 v249, v249, v130
  v_add_f32 v250, v250, v131
  v_cvt_pk_bf16_f32 v41, v130, v131
  s_waitcnt lgkmcnt(3)
  v_mfma_f32_32x32x16_bf16 v[112:127], v[188:191], v[156:159], v[112:127]
  ds_read_b128 v[180:183], v239 offset:2048
  v_exp_f32 v134, v134
  v_exp_f32 v135, v135
  v_add_f32 v249, v249, v132
  v_add_f32 v250, v250, v133
  s_waitcnt lgkmcnt(3)
  v_mfma_f32_32x32x16_bf16 v[112:127], v[192:195], v[160:163], v[112:127]
  ds_read_b64_tr_b16 v[184:185], v248 offset:40960
  ds_read_b64_tr_b16 v[186:187], v248 offset:41472
  v_cvt_pk_bf16_f32 v42, v132, v133
  v_exp_f32 v136, v136
  v_exp_f32 v137, v137
  v_add_f32 v249, v249, v134
  s_waitcnt lgkmcnt(4)
  v_mfma_f32_32x32x16_bf16 v[112:127], v[196:199], v[164:167], v[112:127]
  ds_read_b64_tr_b16 v[188:189], v248 offset:41984
  ds_read_b64_tr_b16 v[190:191], v248 offset:42496
  v_add_f32 v250, v250, v135
  v_cvt_pk_bf16_f32 v43, v134, v135
  v_exp_f32 v138, v138
  v_exp_f32 v139, v139
  s_add_u32 m0, s55, 131072
  s_xor_b32 s64, s59, 98304
  buffer_load_dwordx4 v251, s[12:15], s64 offen offset:0 lds
  s_waitcnt lgkmcnt(5)
  v_mfma_f32_32x32x16_bf16 v[112:127], v[176:179], v[168:171], v[112:127]
  ds_read_b128 v[192:195], v232 offset:18432
  v_add_f32 v249, v249, v136
  v_add_f32 v250, v250, v137
  v_cvt_pk_bf16_f32 v44, v136, v137
  v_exp_f32 v140, v140
  s_waitcnt lgkmcnt(5)
  v_mfma_f32_32x32x16_bf16 v[112:127], v[180:183], v[172:175], v[112:127]
  ds_read_b128 v[196:199], v233 offset:18432
  v_exp_f32 v141, v141
  v_add_f32 v249, v249, v138
  v_add_f32 v250, v250, v139
  v_cvt_pk_bf16_f32 v45, v138, v139
  s_waitcnt lgkmcnt(4)
  v_mfma_f32_32x32x16_bf16 v[216:231], v[184:187], v[32:35], v[216:231]
  ds_read_b128 v[176:179], v234 offset:18432
  v_exp_f32 v142, v142
  v_exp_f32 v143, v143
  v_add_f32 v249, v249, v140
  v_add_f32 v250, v250, v141
  s_add_u32 m0, s55, 131072
  s_xor_b32 s64, s59, 98304
  buffer_load_dwordx4 v252, s[12:15], s64 offen offset:1024 lds
  s_waitcnt lgkmcnt(3)
  v_mfma_f32_32x32x16_bf16 v[216:231], v[188:191], v[36:39], v[216:231]
  ds_read_b128 v[180:183], v235 offset:18432
  v_cvt_pk_bf16_f32 v46, v140, v141
  v_add_f32 v249, v249, v142
  v_add_f32 v250, v250, v143
  v_cvt_pk_bf16_f32 v47, v142, v143
  s_waitcnt lgkmcnt(3)
  v_mfma_f32_32x32x16_bf16 v[128:143], v[192:195], v[144:147], v[200:215]
  ds_read_b128 v[184:187], v236 offset:18432
  v_exp_f32 v112, v112
  v_exp_f32 v113, v113
  v_exp_f32 v114, v114
  v_exp_f32 v115, v115
  s_waitcnt lgkmcnt(3)
  v_mfma_f32_32x32x16_bf16 v[128:143], v[196:199], v[148:151], v[128:143]
  ds_read_b128 v[188:191], v237 offset:18432
  v_add_f32 v249, v249, v112
  v_add_f32 v250, v250, v113
  v_cvt_pk_bf16_f32 v48, v112, v113
  v_exp_f32 v116, v116
  s_waitcnt lgkmcnt(3)
  v_mfma_f32_32x32x16_bf16 v[128:143], v[176:179], v[152:155], v[128:143]
  ds_read_b128 v[192:195], v238 offset:18432
  v_exp_f32 v117, v117
  v_add_f32 v249, v249, v114
  v_add_f32 v250, v250, v115
  v_cvt_pk_bf16_f32 v49, v114, v115
  s_add_u32 m0, s55, 133120
  s_xor_b32 s64, s59, 114688
  buffer_load_dwordx4 v251, s[12:15], s64 offen offset:0 lds
  s_waitcnt lgkmcnt(3)
  v_mfma_f32_32x32x16_bf16 v[128:143], v[180:183], v[156:159], v[128:143]
  ds_read_b128 v[196:199], v239 offset:18432
  v_exp_f32 v118, v118
  v_exp_f32 v119, v119
  v_add_f32 v249, v249, v116
  v_add_f32 v250, v250, v117
  s_waitcnt lgkmcnt(3)
  v_mfma_f32_32x32x16_bf16 v[128:143], v[184:187], v[160:163], v[128:143]
  ds_read_b64_tr_b16 v[176:177], v248 offset:43008
  ds_read_b64_tr_b16 v[178:179], v248 offset:43520
  v_cvt_pk_bf16_f32 v50, v116, v117
  v_exp_f32 v120, v120
  v_exp_f32 v121, v121
  v_add_f32 v249, v249, v118
  s_waitcnt lgkmcnt(4)
  v_mfma_f32_32x32x16_bf16 v[128:143], v[188:191], v[164:167], v[128:143]
  ds_read_b64_tr_b16 v[180:181], v248 offset:44032
  ds_read_b64_tr_b16 v[182:183], v248 offset:44544
  v_add_f32 v250, v250, v119
  v_cvt_pk_bf16_f32 v51, v118, v119
  v_exp_f32 v122, v122
  v_exp_f32 v123, v123
  s_add_u32 m0, s55, 133120
  s_xor_b32 s64, s59, 114688
  buffer_load_dwordx4 v252, s[12:15], s64 offen offset:1024 lds
  s_waitcnt lgkmcnt(5)
  v_mfma_f32_32x32x16_bf16 v[128:143], v[192:195], v[168:171], v[128:143]
  v_add_f32 v249, v249, v120
  v_add_f32 v250, v250, v121
  v_cvt_pk_bf16_f32 v52, v120, v121
  v_exp_f32 v124, v124
  s_waitcnt lgkmcnt(4)
  v_mfma_f32_32x32x16_bf16 v[128:143], v[196:199], v[172:175], v[128:143]
  s_waitcnt vmcnt(10)
  s_waitcnt lgkmcnt(0)
  s_barrier
  ds_read_b128 v[184:187], v232 offset:32768
  ds_read_b128 v[188:191], v233 offset:32768
  v_exp_f32 v125, v125
  v_add_f32 v249, v249, v122
  v_add_f32 v250, v250, v123
  v_cvt_pk_bf16_f32 v53, v122, v123
  v_mfma_f32_32x32x16_bf16 v[216:231], v[176:179], v[40:43], v[216:231]
  ds_read_b128 v[192:195], v234 offset:32768
  v_exp_f32 v126, v126
  v_exp_f32 v127, v127
  v_add_f32 v249, v249, v124
  v_add_f32 v250, v250, v125
  v_mfma_f32_32x32x16_bf16 v[216:231], v[180:183], v[44:47], v[216:231]
  ds_read_b128 v[196:199], v235 offset:32768
  v_cvt_pk_bf16_f32 v54, v124, v125
  v_add_f32 v249, v249, v126
  v_add_f32 v250, v250, v127
  v_cvt_pk_bf16_f32 v55, v126, v127
  s_waitcnt lgkmcnt(3)
  v_mfma_f32_32x32x16_bf16 v[112:127], v[184:187], v[144:147], v[200:215]
  ds_read_b128 v[176:179], v236 offset:32768
  v_exp_f32 v128, v128
  v_exp_f32 v129, v129
  v_exp_f32 v130, v130
  v_exp_f32 v131, v131
  s_waitcnt lgkmcnt(3)
  v_mfma_f32_32x32x16_bf16 v[112:127], v[188:191], v[148:151], v[112:127]
  ds_read_b128 v[180:183], v237 offset:32768
  v_add_f32 v249, v249, v128
  v_add_f32 v250, v250, v129
  v_cvt_pk_bf16_f32 v56, v128, v129
  v_exp_f32 v132, v132
  s_add_u32 m0, s55, 65536
  s_xor_b32 s64, s72, 128
  buffer_load_dwordx4 v253, s[16:19], s64 offen offset:0 lds
  s_waitcnt lgkmcnt(3)
  v_mfma_f32_32x32x16_bf16 v[112:127], v[192:195], v[152:155], v[112:127]
  ds_read_b128 v[184:187], v238 offset:32768
  v_exp_f32 v133, v133
  v_add_f32 v249, v249, v130
  v_add_f32 v250, v250, v131
  v_cvt_pk_bf16_f32 v57, v130, v131
  s_lshr_b32 s68, s56, 5
  s_lshl_b32 s68, s68, 3
  s_add_u32 s68, s68, s52
  s_lshl_b32 s68, s68, 7
  s_add_u32 s68, s68, 32768
  s_waitcnt vmcnt(8)
  s_mov_b32 s96, 1
  s_atomic_add s96, s[98:99], s68
  s_waitcnt lgkmcnt(3)
  v_mfma_f32_32x32x16_bf16 v[112:127], v[196:199], v[156:159], v[112:127]
  ds_read_b128 v[188:191], v239 offset:32768
  v_exp_f32 v134, v134
  v_exp_f32 v135, v135
  v_add_f32 v249, v249, v132
  v_add_f32 v250, v250, v133
  s_waitcnt lgkmcnt(3)
  v_mfma_f32_32x32x16_bf16 v[112:127], v[176:179], v[160:163], v[112:127]
  ds_read_b64_tr_b16 v[192:193], v248 offset:45056
  ds_read_b64_tr_b16 v[194:195], v248 offset:45568
  v_cvt_pk_bf16_f32 v58, v132, v133
  v_exp_f32 v136, v136
  v_exp_f32 v137, v137
  v_add_f32 v249, v249, v134
  s_waitcnt lgkmcnt(4)
  v_mfma_f32_32x32x16_bf16 v[112:127], v[180:183], v[164:167], v[112:127]
  ds_read_b64_tr_b16 v[196:197], v248 offset:46080
  ds_read_b64_tr_b16 v[198:199], v248 offset:46592
  v_add_f32 v250, v250, v135
  v_cvt_pk_bf16_f32 v59, v134, v135
  v_exp_f32 v138, v138
  v_exp_f32 v139, v139
  s_waitcnt lgkmcnt(5)
  v_mfma_f32_32x32x16_bf16 v[112:127], v[184:187], v[168:171], v[112:127]
  ds_read_b128 v[176:179], v232 offset:49152
  v_add_f32 v249, v249, v136
  v_add_f32 v250, v250, v137
  v_cvt_pk_bf16_f32 v60, v136, v137
  v_exp_f32 v140, v140
  s_add_u32 m0, s55, 66560
  s_xor_b32 s64, s72, 4224
  buffer_load_dwordx4 v253, s[16:19], s64 offen offset:0 lds
  s_waitcnt lgkmcnt(5)
  v_mfma_f32_32x32x16_bf16 v[112:127], v[188:191], v[172:175], v[112:127]
  ds_read_b128 v[180:183], v233 offset:49152
  v_exp_f32 v141, v141
  v_add_f32 v249, v249, v138
  v_add_f32 v250, v250, v139
  v_cvt_pk_bf16_f32 v61, v138, v139
  s_waitcnt lgkmcnt(4)
  v_mfma_f32_32x32x16_bf16 v[216:231], v[192:195], v[48:51], v[216:231]
  ds_read_b128 v[184:187], v234 offset:49152
  v_exp_f32 v142, v142
  v_exp_f32 v143, v143
  v_add_f32 v249, v249, v140
  v_add_f32 v250, v250, v141
  s_waitcnt lgkmcnt(3)
  v_mfma_f32_32x32x16_bf16 v[216:231], v[196:199], v[52:55], v[216:231]
  ds_read_b128 v[188:191], v235 offset:49152
  v_cvt_pk_bf16_f32 v62, v140, v141
  v_add_f32 v249, v249, v142
  v_add_f32 v250, v250, v143
  v_cvt_pk_bf16_f32 v63, v142, v143
  s_waitcnt lgkmcnt(3)
  v_mfma_f32_32x32x16_bf16 v[128:143], v[176:179], v[144:147], v[200:215]
  ds_read_b128 v[192:195], v236 offset:49152
  v_exp_f32 v112, v112
  v_exp_f32 v113, v113
  v_exp_f32 v114, v114
  v_exp_f32 v115, v115
  s_waitcnt lgkmcnt(3)
  v_mfma_f32_32x32x16_bf16 v[128:143], v[180:183], v[148:151], v[128:143]
  ds_read_b128 v[196:199], v237 offset:49152
  v_add_f32 v249, v249, v112
  v_add_f32 v250, v250, v113
  v_cvt_pk_bf16_f32 v64, v112, v113
  v_exp_f32 v116, v116
  s_waitcnt lgkmcnt(3)
  v_mfma_f32_32x32x16_bf16 v[128:143], v[184:187], v[152:155], v[128:143]
  ds_read_b128 v[176:179], v238 offset:49152
  v_exp_f32 v117, v117
  v_add_f32 v249, v249, v114
  v_add_f32 v250, v250, v115
  v_cvt_pk_bf16_f32 v65, v114, v115
  s_add_u32 m0, s55, 67584
  s_xor_b32 s64, s72, 8320
  buffer_load_dwordx4 v253, s[16:19], s64 offen offset:0 lds
  s_waitcnt lgkmcnt(3)
  v_mfma_f32_32x32x16_bf16 v[128:143], v[188:191], v[156:159], v[128:143]
  ds_read_b128 v[180:183], v239 offset:49152
  v_exp_f32 v118, v118
  v_exp_f32 v119, v119
  v_add_f32 v249, v249, v116
  v_add_f32 v250, v250, v117
  s_min_u32 s71, s73, 175
  s_and_b32 s65, s71, 7
  s_lshl_b32 s65, s65, 3
  s_add_u32 s65, s65, s52
  s_lshl_b32 s65, s65, 3
  v_lshrrev_b32 v105, 3, v255
  v_add_u32 v105, s65, v105
  v_mul_u32_u24 v105, 2752, v105
  v_and_b32 v107, 7, v255
  v_lshl_add_u32 v105, v107, 4, v105
  s_lshr_b32 s65, s71, 3
  s_lshl_b32 s65, s65, 7
  buffer_load_dwordx4 v[240:243], v105, s[40:43], s65 offen
  buffer_load_dwordx4 v[244:247], v105, s[44:47], s65 offen
  s_waitcnt lgkmcnt(3)
  v_mfma_f32_32x32x16_bf16 v[128:143], v[192:195], v[160:163], v[128:143]
  ds_read_b64_tr_b16 v[184:185], v248 offset:47104
  ds_read_b64_tr_b16 v[186:187], v248 offset:47616
  v_cvt_pk_bf16_f32 v66, v116, v117
  v_exp_f32 v120, v120
  v_exp_f32 v121, v121
  v_add_f32 v249, v249, v118
  s_waitcnt lgkmcnt(4)
  v_mfma_f32_32x32x16_bf16 v[128:143], v[196:199], v[164:167], v[128:143]
  ds_read_b64_tr_b16 v[188:189], v248 offset:48128
  ds_read_b64_tr_b16 v[190:191], v248 offset:48640
  v_add_f32 v250, v250, v119
  v_cvt_pk_bf16_f32 v67, v118, v119
  v_exp_f32 v122, v122
  v_exp_f32 v123, v123
  s_waitcnt lgkmcnt(5)
  v_mfma_f32_32x32x16_bf16 v[128:143], v[176:179], v[168:171], v[128:143]
  ds_read_b128 v[192:195], v232 offset:34816
  v_add_f32 v249, v249, v120
  v_add_f32 v250, v250, v121
  v_cvt_pk_bf16_f32 v68, v120, v121
  v_exp_f32 v124, v124
  s_waitcnt lgkmcnt(5)
  v_mfma_f32_32x32x16_bf16 v[128:143], v[180:183], v[172:175], v[128:143]
  ds_read_b128 v[196:199], v233 offset:34816
  v_exp_f32 v125, v125
  v_add_f32 v249, v249, v122
  v_add_f32 v250, v250, v123
  v_cvt_pk_bf16_f32 v69, v122, v123
  s_waitcnt lgkmcnt(4)
  v_mfma_f32_32x32x16_bf16 v[216:231], v[184:187], v[56:59], v[216:231]
  ds_read_b128 v[176:179], v234 offset:34816
  v_exp_f32 v126, v126
  v_exp_f32 v127, v127
  v_add_f32 v249, v249, v124
  v_add_f32 v250, v250, v125
  s_add_u32 m0, s55, 68608
  s_xor_b32 s64, s72, 12416
  buffer_load_dwordx4 v253, s[16:19], s64 offen offset:0 lds
  s_waitcnt lgkmcnt(3)
  v_mfma_f32_32x32x16_bf16 v[216:231], v[188:191], v[60:63], v[216:231]
  ds_read_b128 v[180:183], v235 offset:34816
  v_cvt_pk_bf16_f32 v70, v124, v125
  v_add_f32 v249, v249, v126
  v_add_f32 v250, v250, v127
  v_cvt_pk_bf16_f32 v71, v126, v127
  s_waitcnt lgkmcnt(3)
  v_mfma_f32_32x32x16_bf16 v[112:127], v[192:195], v[144:147], v[200:215]
  ds_read_b128 v[184:187], v236 offset:34816
  v_exp_f32 v128, v128
  v_exp_f32 v129, v129
  v_exp_f32 v130, v130
  v_exp_f32 v131, v131
  s_waitcnt lgkmcnt(3)
  v_mfma_f32_32x32x16_bf16 v[112:127], v[196:199], v[148:151], v[112:127]
  ds_read_b128 v[188:191], v237 offset:34816
  v_add_f32 v249, v249, v128
  v_add_f32 v250, v250, v129
  v_cvt_pk_bf16_f32 v72, v128, v129
  v_exp_f32 v132, v132
  s_waitcnt lgkmcnt(3)
  v_mfma_f32_32x32x16_bf16 v[112:127], v[176:179], v[152:155], v[112:127]
  ds_read_b128 v[192:195], v238 offset:34816
  v_exp_f32 v133, v133
  v_add_f32 v249, v249, v130
  v_add_f32 v250, v250, v131
  v_cvt_pk_bf16_f32 v73, v130, v131
  s_waitcnt lgkmcnt(3)
  v_mfma_f32_32x32x16_bf16 v[112:127], v[180:183], v[156:159], v[112:127]
  ds_read_b128 v[196:199], v239 offset:34816
  v_exp_f32 v134, v134
  v_exp_f32 v135, v135
  v_add_f32 v249, v249, v132
  v_add_f32 v250, v250, v133
  s_waitcnt lgkmcnt(3)
  v_mfma_f32_32x32x16_bf16 v[112:127], v[184:187], v[160:163], v[112:127]
  ds_read_b64_tr_b16 v[176:177], v248 offset:49152
  ds_read_b64_tr_b16 v[178:179], v248 offset:49664
  v_cvt_pk_bf16_f32 v74, v132, v133
  v_exp_f32 v136, v136
  v_exp_f32 v137, v137
  v_add_f32 v249, v249, v134
  s_waitcnt lgkmcnt(4)
  v_mfma_f32_32x32x16_bf16 v[112:127], v[188:191], v[164:167], v[112:127]
  ds_read_b64_tr_b16 v[180:181], v248 offset:50176
  ds_read_b64_tr_b16 v[182:183], v248 offset:50688
  v_add_f32 v250, v250, v135
  v_cvt_pk_bf16_f32 v75, v134, v135
  v_exp_f32 v138, v138
  v_exp_f32 v139, v139
  s_waitcnt lgkmcnt(5)
  v_mfma_f32_32x32x16_bf16 v[112:127], v[192:195], v[168:171], v[112:127]
  ds_read_b128 v[184:187], v232 offset:51200
  v_add_f32 v249, v249, v136
  v_add_f32 v250, v250, v137
  v_cvt_pk_bf16_f32 v76, v136, v137
  v_exp_f32 v140, v140
  s_waitcnt lgkmcnt(5)
  v_mfma_f32_32x32x16_bf16 v[112:127], v[196:199], v[172:175], v[112:127]
  ds_read_b128 v[188:191], v233 offset:51200
  v_exp_f32 v141, v141
  v_add_f32 v249, v249, v138
  v_add_f32 v250, v250, v139
  v_cvt_pk_bf16_f32 v77, v138, v139
  s_waitcnt lgkmcnt(4)
  v_mfma_f32_32x32x16_bf16 v[216:231], v[176:179], v[64:67], v[216:231]
  ds_read_b128 v[192:195], v234 offset:51200
  v_exp_f32 v142, v142
  v_exp_f32 v143, v143
  v_add_f32 v249, v249, v140
  v_add_f32 v250, v250, v141
  s_waitcnt lgkmcnt(3)
  v_mfma_f32_32x32x16_bf16 v[216:231], v[180:183], v[68:71], v[216:231]
  ds_read_b128 v[196:199], v235 offset:51200
  v_cvt_pk_bf16_f32 v78, v140, v141
  v_add_f32 v249, v249, v142
  v_add_f32 v250, v250, v143
  v_cvt_pk_bf16_f32 v79, v142, v143
  s_waitcnt lgkmcnt(3)
  v_mfma_f32_32x32x16_bf16 v[128:143], v[184:187], v[144:147], v[200:215]
  ds_read_b128 v[176:179], v236 offset:51200
  v_exp_f32 v112, v112
  v_exp_f32 v113, v113
  v_exp_f32 v114, v114
  v_exp_f32 v115, v115
  s_waitcnt lgkmcnt(3)
  v_mfma_f32_32x32x16_bf16 v[128:143], v[188:191], v[148:151], v[128:143]
  ds_read_b128 v[180:183], v237 offset:51200
  v_add_f32 v249, v249, v112
  v_add_f32 v250, v250, v113
  v_cvt_pk_bf16_f32 v80, v112, v113
  v_exp_f32 v116, v116
  s_waitcnt lgkmcnt(3)
  v_mfma_f32_32x32x16_bf16 v[128:143], v[192:195], v[152:155], v[128:143]
  ds_read_b128 v[184:187], v238 offset:51200
  v_exp_f32 v117, v117
  v_add_f32 v249, v249, v114
  v_add_f32 v250, v250, v115
  v_cvt_pk_bf16_f32 v81, v114, v115
  s_waitcnt lgkmcnt(3)
  v_mfma_f32_32x32x16_bf16 v[128:143], v[196:199], v[156:159], v[128:143]
  ds_read_b128 v[188:191], v239 offset:51200
  v_exp_f32 v118, v118
  v_exp_f32 v119, v119
  v_add_f32 v249, v249, v116
  v_add_f32 v250, v250, v117
  s_waitcnt lgkmcnt(3)
  v_mfma_f32_32x32x16_bf16 v[128:143], v[176:179], v[160:163], v[128:143]
  ds_read_b64_tr_b16 v[192:193], v248 offset:51200
  ds_read_b64_tr_b16 v[194:195], v248 offset:51712
  v_cvt_pk_bf16_f32 v82, v116, v117
  v_exp_f32 v120, v120
  v_exp_f32 v121, v121
  v_add_f32 v249, v249, v118
  s_waitcnt lgkmcnt(4)
  v_mfma_f32_32x32x16_bf16 v[128:143], v[180:183], v[164:167], v[128:143]
  ds_read_b64_tr_b16 v[196:197], v248 offset:52224
  ds_read_b64_tr_b16 v[198:199], v248 offset:52736
  v_add_f32 v250, v250, v119
  v_cvt_pk_bf16_f32 v83, v118, v119
  v_exp_f32 v122, v122
  v_exp_f32 v123, v123
  s_waitcnt lgkmcnt(5)
  v_mfma_f32_32x32x16_bf16 v[128:143], v[184:187], v[168:171], v[128:143]
  v_add_f32 v249, v249, v120
  v_add_f32 v250, v250, v121
  v_cvt_pk_bf16_f32 v84, v120, v121
  v_exp_f32 v124, v124
  s_waitcnt lgkmcnt(4)
  v_mfma_f32_32x32x16_bf16 v[128:143], v[188:191], v[172:175], v[128:143]
  v_add_u32 v232, 65536, v232
  v_add_u32 v233, 65536, v233
  v_add_u32 v234, 65536, v234
  v_add_u32 v235, 65536, v235
  v_add_u32 v236, 65536, v236
  v_add_u32 v237, 65536, v237
  v_add_u32 v238, 65536, v238
  v_add_u32 v239, 65536, v239
  s_waitcnt vmcnt(6)
  s_waitcnt lgkmcnt(0)
  s_barrier
  ds_read_b128 v[176:179], v232 offset:0
  ds_read_b128 v[180:183], v233 offset:0
  v_exp_f32 v125, v125
  v_add_f32 v249, v249, v122
  v_add_f32 v250, v250, v123
  v_cvt_pk_bf16_f32 v85, v122, v123
  v_mfma_f32_32x32x16_bf16 v[216:231], v[192:195], v[72:75], v[216:231]
  ds_read_b128 v[184:187], v234 offset:0
  v_exp_f32 v126, v126
  v_exp_f32 v127, v127
  v_add_f32 v249, v249, v124
  v_add_f32 v250, v250, v125
  v_mfma_f32_32x32x16_bf16 v[216:231], v[196:199], v[76:79], v[216:231]
  ds_read_b128 v[188:191], v235 offset:0
  v_cvt_pk_bf16_f32 v86, v124, v125
  v_add_f32 v249, v249, v126
  v_add_f32 v250, v250, v127
  v_cvt_pk_bf16_f32 v87, v126, v127
  s_waitcnt lgkmcnt(3)
  v_mfma_f32_32x32x16_bf16 v[112:127], v[176:179], v[144:147], v[200:215]
  ds_read_b128 v[192:195], v236 offset:0
  v_exp_f32 v128, v128
  v_exp_f32 v129, v129
  v_exp_f32 v130, v130
  v_exp_f32 v131, v131
  s_waitcnt lgkmcnt(3)
  v_mfma_f32_32x32x16_bf16 v[112:127], v[180:183], v[148:151], v[112:127]
  ds_read_b128 v[196:199], v237 offset:0
  v_add_f32 v249, v249, v128
  v_add_f32 v250, v250, v129
  v_cvt_pk_bf16_f32 v88, v128, v129
  v_exp_f32 v132, v132
  s_add_u32 m0, s55, 98304
  s_xor_b32 s64, s72, 192
  buffer_load_dwordx4 v253, s[16:19], s64 offen offset:0 lds
  s_waitcnt lgkmcnt(3)
  v_mfma_f32_32x32x16_bf16 v[112:127], v[184:187], v[152:155], v[112:127]
  ds_read_b128 v[176:179], v238 offset:0
  v_exp_f32 v133, v133
  v_add_f32 v249, v249, v130
  v_add_f32 v250, v250, v131
  v_cvt_pk_bf16_f32 v89, v130, v131
  s_waitcnt lgkmcnt(3)
  v_mfma_f32_32x32x16_bf16 v[112:127], v[188:191], v[156:159], v[112:127]
  ds_read_b128 v[180:183], v239 offset:0
  v_exp_f32 v134, v134
  v_exp_f32 v135, v135
  v_add_f32 v249, v249, v132
  v_add_f32 v250, v250, v133
  s_waitcnt lgkmcnt(3)
  v_mfma_f32_32x32x16_bf16 v[112:127], v[192:195], v[160:163], v[112:127]
  ds_read_b64_tr_b16 v[184:185], v248 offset:53248
  ds_read_b64_tr_b16 v[186:187], v248 offset:53760
  v_cvt_pk_bf16_f32 v90, v132, v133
  v_exp_f32 v136, v136
  v_exp_f32 v137, v137
  v_add_f32 v249, v249, v134
  s_waitcnt lgkmcnt(4)
  v_mfma_f32_32x32x16_bf16 v[112:127], v[196:199], v[164:167], v[112:127]
  ds_read_b64_tr_b16 v[188:189], v248 offset:54272
  ds_read_b64_tr_b16 v[190:191], v248 offset:54784
  v_add_f32 v250, v250, v135
  v_cvt_pk_bf16_f32 v91, v134, v135
  v_exp_f32 v138, v138
  v_exp_f32 v139, v139
  s_waitcnt lgkmcnt(5)
  v_mfma_f32_32x32x16_bf16 v[112:127], v[176:179], v[168:171], v[112:127]
  ds_read_b128 v[192:195], v232 offset:16384
  v_add_f32 v249, v249, v136
  v_add_f32 v250, v250, v137
  v_cvt_pk_bf16_f32 v92, v136, v137
  v_exp_f32 v140, v140
  s_add_u32 m0, s55, 99328
  s_xor_b32 s64, s72, 4288
  buffer_load_dwordx4 v253, s[16:19], s64 offen offset:0 lds
  s_waitcnt lgkmcnt(5)
  v_mfma_f32_32x32x16_bf16 v[112:127], v[180:183], v[172:175], v[112:127]
  ds_read_b128 v[196:199], v233 offset:16384
  v_exp_f32 v141, v141
  v_add_f32 v249, v249, v138
  v_add_f32 v250, v250, v139
  v_cvt_pk_bf16_f32 v93, v138, v139
  s_waitcnt lgkmcnt(4)
  v_mfma_f32_32x32x16_bf16 v[216:231], v[184:187], v[80:83], v[216:231]
  ds_read_b128 v[176:179], v234 offset:16384
  v_exp_f32 v142, v142
  v_exp_f32 v143, v143
  v_add_f32 v249, v249, v140
  v_add_f32 v250, v250, v141
  s_waitcnt lgkmcnt(3)
  v_mfma_f32_32x32x16_bf16 v[216:231], v[188:191], v[84:87], v[216:231]
  ds_read_b128 v[180:183], v235 offset:16384
  v_cvt_pk_bf16_f32 v94, v140, v141
  v_add_f32 v249, v249, v142
  v_add_f32 v250, v250, v143
  v_cvt_pk_bf16_f32 v95, v142, v143
  s_waitcnt lgkmcnt(3)
  v_mfma_f32_32x32x16_bf16 v[128:143], v[192:195], v[144:147], v[200:215]
  ds_read_b128 v[184:187], v236 offset:16384
  v_exp_f32 v112, v112
  v_exp_f32 v113, v113
  v_exp_f32 v114, v114
  v_exp_f32 v115, v115
  s_lshl_b32 s70, s52, 3
  s_add_u32 s70, s70, s63
  s_lshl_b32 s70, s70, 7
  s_add_u32 s70, s70, 32768
  s_load_dword s97, s[98:99], s70 glc
  s_waitcnt lgkmcnt(3)
  v_mfma_f32_32x32x16_bf16 v[128:143], v[196:199], v[148:151], v[128:143]
  ds_read_b128 v[188:191], v237 offset:16384
  v_add_f32 v249, v249, v112
  v_add_f32 v250, v250, v113
  v_cvt_pk_bf16_f32 v96, v112, v113
  v_exp_f32 v116, v116
  s_waitcnt lgkmcnt(3)
  v_mfma_f32_32x32x16_bf16 v[128:143], v[176:179], v[152:155], v[128:143]
  ds_read_b128 v[192:195], v238 offset:16384
  v_exp_f32 v117, v117
  v_add_f32 v249, v249, v114
  v_add_f32 v250, v250, v115
  v_cvt_pk_bf16_f32 v97, v114, v115
  s_add_u32 m0, s55, 100352
  s_xor_b32 s64, s72, 8384
  buffer_load_dwordx4 v253, s[16:19], s64 offen offset:0 lds
  s_waitcnt lgkmcnt(3)
  v_mfma_f32_32x32x16_bf16 v[128:143], v[180:183], v[156:159], v[128:143]
  ds_read_b128 v[196:199], v239 offset:16384
  v_exp_f32 v118, v118
  v_exp_f32 v119, v119
  v_add_f32 v249, v249, v116
  v_add_f32 v250, v250, v117
  s_waitcnt lgkmcnt(3)
  v_mfma_f32_32x32x16_bf16 v[128:143], v[184:187], v[160:163], v[128:143]
  ds_read_b64_tr_b16 v[176:177], v248 offset:55296
  ds_read_b64_tr_b16 v[178:179], v248 offset:55808
  v_cvt_pk_bf16_f32 v98, v116, v117
  v_exp_f32 v120, v120
  v_exp_f32 v121, v121
  v_add_f32 v249, v249, v118
  s_waitcnt lgkmcnt(4)
  v_mfma_f32_32x32x16_bf16 v[128:143], v[188:191], v[164:167], v[128:143]
  ds_read_b64_tr_b16 v[180:181], v248 offset:56320
  ds_read_b64_tr_b16 v[182:183], v248 offset:56832
  v_add_f32 v250, v250, v119
  v_cvt_pk_bf16_f32 v99, v118, v119
  v_exp_f32 v122, v122
  v_exp_f32 v123, v123
  s_waitcnt lgkmcnt(5)
  v_mfma_f32_32x32x16_bf16 v[128:143], v[192:195], v[168:171], v[128:143]
  ds_read_b128 v[184:187], v232 offset:2048
  v_add_f32 v249, v249, v120
  v_add_f32 v250, v250, v121
  v_cvt_pk_bf16_f32 v100, v120, v121
  v_exp_f32 v124, v124
  s_waitcnt lgkmcnt(5)
  v_mfma_f32_32x32x16_bf16 v[128:143], v[196:199], v[172:175], v[128:143]
  ds_read_b128 v[188:191], v233 offset:2048
  v_exp_f32 v125, v125
  v_add_f32 v249, v249, v122
  v_add_f32 v250, v250, v123
  v_cvt_pk_bf16_f32 v101, v122, v123
  s_waitcnt lgkmcnt(4)
  v_mfma_f32_32x32x16_bf16 v[216:231], v[176:179], v[88:91], v[216:231]
  ds_read_b128 v[192:195], v234 offset:2048
  v_exp_f32 v126, v126
  v_exp_f32 v127, v127
  v_add_f32 v249, v249, v124
  v_add_f32 v250, v250, v125
  s_add_u32 m0, s55, 101376
  s_xor_b32 s64, s72, 12480
  buffer_load_dwordx4 v253, s[16:19], s64 offen offset:0 lds
  s_waitcnt lgkmcnt(3)
  v_mfma_f32_32x32x16_bf16 v[216:231], v[180:183], v[92:95], v[216:231]
  ds_read_b128 v[196:199], v235 offset:2048
  v_cvt_pk_bf16_f32 v102, v124, v125
  v_add_f32 v249, v249, v126
  v_add_f32 v250, v250, v127
  v_cvt_pk_bf16_f32 v103, v126, v127
  s_waitcnt lgkmcnt(3)
  v_mfma_f32_32x32x16_bf16 v[112:127], v[184:187], v[144:147], v[200:215]
  ds_read_b128 v[176:179], v236 offset:2048
  v_exp_f32 v128, v128
  v_exp_f32 v129, v129
  v_exp_f32 v130, v130
  v_exp_f32 v131, v131
  s_waitcnt lgkmcnt(3)
  v_mfma_f32_32x32x16_bf16 v[112:127], v[188:191], v[148:151], v[112:127]
  ds_read_b128 v[180:183], v237 offset:2048
  v_add_f32 v249, v249, v128
  v_add_f32 v250, v250, v129
  v_cvt_pk_bf16_f32 v104, v128, v129
  v_exp_f32 v132, v132
  s_waitcnt lgkmcnt(3)
  v_mfma_f32_32x32x16_bf16 v[112:127], v[192:195], v[152:155], v[112:127]
  ds_read_b128 v[184:187], v238 offset:2048
  v_exp_f32 v133, v133
  v_add_f32 v249, v249, v130
  v_add_f32 v250, v250, v131
  v_cvt_pk_bf16_f32 v105, v130, v131
  s_waitcnt lgkmcnt(3)
  v_mfma_f32_32x32x16_bf16 v[112:127], v[196:199], v[156:159], v[112:127]
  ds_read_b128 v[188:191], v239 offset:2048
  v_exp_f32 v134, v134
  v_exp_f32 v135, v135
  v_add_f32 v249, v249, v132
  v_add_f32 v250, v250, v133
  s_waitcnt lgkmcnt(3)
  v_mfma_f32_32x32x16_bf16 v[112:127], v[176:179], v[160:163], v[112:127]
  ds_read_b64_tr_b16 v[192:193], v248 offset:57344
  ds_read_b64_tr_b16 v[194:195], v248 offset:57856
  v_cvt_pk_bf16_f32 v106, v132, v133
  v_exp_f32 v136, v136
  v_exp_f32 v137, v137
  v_add_f32 v249, v249, v134
  s_waitcnt lgkmcnt(4)
  v_mfma_f32_32x32x16_bf16 v[112:127], v[180:183], v[164:167], v[112:127]
  ds_read_b64_tr_b16 v[196:197], v248 offset:58368
  ds_read_b64_tr_b16 v[198:199], v248 offset:58880
  v_add_f32 v250, v250, v135
  v_cvt_pk_bf16_f32 v107, v134, v135
  v_exp_f32 v138, v138
  v_exp_f32 v139, v139
  s_waitcnt lgkmcnt(5)
  v_mfma_f32_32x32x16_bf16 v[112:127], v[184:187], v[168:171], v[112:127]
  ds_read_b128 v[176:179], v232 offset:18432
  v_add_f32 v249, v249, v136
  v_add_f32 v250, v250, v137
  v_cvt_pk_bf16_f32 v108, v136, v137
  v_exp_f32 v140, v140
  s_waitcnt lgkmcnt(5)
  v_mfma_f32_32x32x16_bf16 v[112:127], v[188:191], v[172:175], v[112:127]
  ds_read_b128 v[180:183], v233 offset:18432
  v_exp_f32 v141, v141
  v_add_f32 v249, v249, v138
  v_add_f32 v250, v250, v139
  v_cvt_pk_bf16_f32 v109, v138, v139
  s_waitcnt lgkmcnt(4)
  v_mfma_f32_32x32x16_bf16 v[216:231], v[192:195], v[96:99], v[216:231]
  ds_read_b128 v[184:187], v234 offset:18432
  v_exp_f32 v142, v142
  v_exp_f32 v143, v143
  v_add_f32 v249, v249, v140
  v_add_f32 v250, v250, v141
  v_lshlrev_b32 v251, 4, v255
  v_add_u32 v252, s55, v251
  s_waitcnt lgkmcnt(3)
  v_mfma_f32_32x32x16_bf16 v[216:231], v[196:199], v[100:103], v[216:231]
  ds_read_b128 v[188:191], v235 offset:18432
  v_cvt_pk_bf16_f32 v110, v140, v141
  v_add_f32 v249, v249, v142
  v_add_f32 v250, v250, v143
  v_cvt_pk_bf16_f32 v111, v142, v143
  s_waitcnt lgkmcnt(3)
  v_mfma_f32_32x32x16_bf16 v[128:143], v[176:179], v[144:147], v[200:215]
  ds_read_b128 v[192:195], v236 offset:18432
  v_exp_f32 v112, v112
  v_exp_f32 v113, v113
  v_exp_f32 v114, v114
  v_exp_f32 v115, v115
  s_waitcnt lgkmcnt(3)
  v_mfma_f32_32x32x16_bf16 v[128:143], v[180:183], v[148:151], v[128:143]
  ds_read_b128 v[196:199], v237 offset:18432
  v_add_f32 v249, v249, v112
  v_add_f32 v250, v250, v113
  v_cvt_pk_bf16_f32 v112, v112, v113
  v_exp_f32 v116, v116
  s_waitcnt lgkmcnt(3)
  v_mfma_f32_32x32x16_bf16 v[128:143], v[184:187], v[152:155], v[128:143]
  ds_read_b128 v[176:179], v238 offset:18432
  v_exp_f32 v117, v117
  v_add_f32 v249, v249, v114
  v_add_f32 v250, v250, v115
  v_cvt_pk_bf16_f32 v113, v114, v115
  s_waitcnt lgkmcnt(3)
  v_mfma_f32_32x32x16_bf16 v[128:143], v[188:191], v[156:159], v[128:143]
  ds_read_b128 v[180:183], v239 offset:18432
  v_exp_f32 v118, v118
  v_exp_f32 v119, v119
  v_add_f32 v249, v249, v116
  v_add_f32 v250, v250, v117
  s_waitcnt lgkmcnt(3)
  v_mfma_f32_32x32x16_bf16 v[128:143], v[192:195], v[160:163], v[128:143]
  ds_read_b64_tr_b16 v[184:185], v248 offset:59392
  ds_read_b64_tr_b16 v[186:187], v248 offset:59904
  v_cvt_pk_bf16_f32 v114, v116, v117
  v_exp_f32 v120, v120
  v_exp_f32 v121, v121
  v_add_f32 v249, v249, v118
  s_waitcnt lgkmcnt(4)
  v_mfma_f32_32x32x16_bf16 v[128:143], v[196:199], v[164:167], v[128:143]
  ds_read_b64_tr_b16 v[188:189], v248 offset:60416
  ds_read_b64_tr_b16 v[190:191], v248 offset:60928
  v_add_f32 v250, v250, v119
  v_cvt_pk_bf16_f32 v115, v118, v119
  v_exp_f32 v122, v122
  v_exp_f32 v123, v123
  s_waitcnt lgkmcnt(5)
  v_mfma_f32_32x32x16_bf16 v[128:143], v[176:179], v[168:171], v[128:143]
  v_add_f32 v249, v249, v120
  v_add_f32 v250, v250, v121
  v_cvt_pk_bf16_f32 v116, v120, v121
  v_exp_f32 v124, v124
  s_waitcnt lgkmcnt(4)
  v_mfma_f32_32x32x16_bf16 v[128:143], v[180:183], v[172:175], v[128:143]
  s_waitcnt lgkmcnt(0)
  s_barrier
  s_waitcnt lgkmcnt(0)
  s_mov_b32 s80, 0
Lspin_7:
  s_bfe_u32 s65, s97, 0x80000
  s_cmp_eq_u32 s65, 32
  s_cbranch_scc1 Lok_8
  s_sleep 4
  s_load_dword s97, s[98:99], s70 glc
  s_waitcnt lgkmcnt(0)
  s_add_u32 s80, s80, 1
  s_cmp_lt_u32 s80, 0x80000
  s_cbranch_scc1 Lspin_7
Lok_8:
  ds_read_b64_tr_b16 v[192:193], v248 offset:0
  ds_read_b64_tr_b16 v[194:195], v248 offset:512
  ds_read_b64_tr_b16 v[196:197], v248 offset:1024
  ds_read_b64_tr_b16 v[198:199], v248 offset:1536
  v_exp_f32 v125, v125
  v_add_f32 v249, v249, v122
  v_add_f32 v250, v250, v123
  v_cvt_pk_bf16_f32 v117, v122, v123
  v_mfma_f32_32x32x16_bf16 v[216:231], v[184:187], v[104:107], v[216:231]
  ds_read_b64_tr_b16 v[176:177], v248 offset:2048
  ds_read_b64_tr_b16 v[178:179], v248 offset:2560
  v_exp_f32 v126, v126
  v_exp_f32 v127, v127
  v_add_f32 v249, v249, v124
  v_add_f32 v250, v250, v125
  v_mfma_f32_32x32x16_bf16 v[216:231], v[188:191], v[108:111], v[216:231]
  ds_read_b64_tr_b16 v[180:181], v248 offset:3072
  ds_read_b64_tr_b16 v[182:183], v248 offset:3584
  v_cvt_pk_bf16_f32 v118, v124, v125
  v_add_f32 v249, v249, v126
  v_add_f32 v250, v250, v127
  v_cvt_pk_bf16_f32 v119, v126, v127
  s_add_u32 s64, s60, 0
  buffer_load_dwordx4 v[232:235], v251, s[24:27], s64 offen offset:0 sc1
  s_waitcnt lgkmcnt(6)
  v_mfma_f32_32x32x16_bf16 v[200:215], v[192:195], v[0:3], 0
  ds_read_b64_tr_b16 v[184:185], v248 offset:4096
  ds_read_b64_tr_b16 v[186:187], v248 offset:4608
  v_exp_f32 v128, v128
  v_exp_f32 v129, v129
  v_exp_f32 v130, v130
  v_exp_f32 v131, v131
  s_waitcnt lgkmcnt(6)
  v_mfma_f32_32x32x16_bf16 v[200:215], v[196:199], v[4:7], v[200:215]
  ds_read_b64_tr_b16 v[188:189], v248 offset:5120
  ds_read_b64_tr_b16 v[190:191], v248 offset:5632
  v_add_f32 v249, v249, v128
  v_add_f32 v250, v250, v129
  v_cvt_pk_bf16_f32 v128, v128, v129
  v_exp_f32 v132, v132
  s_waitcnt lgkmcnt(6)
  v_mfma_f32_32x32x16_bf16 v[200:215], v[176:179], v[8:11], v[200:215]
  ds_read_b64_tr_b16 v[192:193], v248 offset:6144
  ds_read_b64_tr_b16 v[194:195], v248 offset:6656
  v_exp_f32 v133, v133
  v_add_f32 v249, v249, v130
  v_add_f32 v250, v250, v131
  v_cvt_pk_bf16_f32 v129, v130, v131
  s_add_u32 s64, s60, 0
  buffer_load_dwordx4 v[236:239], v251, s[24:27], s64 offen offset:1024 sc1
  s_waitcnt lgkmcnt(6)
  v_mfma_f32_32x32x16_bf16 v[200:215], v[180:183], v[12:15], v[200:215]
  ds_read_b64_tr_b16 v[196:197], v248 offset:7168
  ds_read_b64_tr_b16 v[198:199], v248 offset:7680
  v_exp_f32 v134, v134
  v_exp_f32 v135, v135
  v_add_f32 v249, v249, v132
  v_add_f32 v250, v250, v133
  s_waitcnt lgkmcnt(6)
  v_mfma_f32_32x32x16_bf16 v[200:215], v[184:187], v[16:19], v[200:215]
  ds_read_b64_tr_b16 v[176:177], v248 offset:8192
  ds_read_b64_tr_b16 v[178:179], v248 offset:8704
  v_cvt_pk_bf16_f32 v130, v132, v133
  v_exp_f32 v136, v136
  v_exp_f32 v137, v137
  v_add_f32 v249, v249, v134
  s_waitcnt lgkmcnt(6)
  v_mfma_f32_32x32x16_bf16 v[200:215], v[188:191], v[20:23], v[200:215]
  ds_read_b64_tr_b16 v[180:181], v248 offset:9216
  ds_read_b64_tr_b16 v[182:183], v248 offset:9728
  v_add_f32 v250, v250, v135
  v_cvt_pk_bf16_f32 v131, v134, v135
  v_exp_f32 v138, v138
  v_exp_f32 v139, v139
  s_add_u32 m0, s55, 131072
  s_xor_b32 s64, s60, 36864
  buffer_load_dwordx4 v251, s[24:27], s64 offen offset:0 sc1 lds
  s_waitcnt lgkmcnt(6)
  v_mfma_f32_32x32x16_bf16 v[200:215], v[192:195], v[24:27], v[200:215]
  ds_read_b64_tr_b16 v[184:185], v248 offset:61440
  ds_read_b64_tr_b16 v[186:187], v248 offset:61952
  v_add_f32 v249, v249, v136
  v_add_f32 v250, v250, v137
  v_cvt_pk_bf16_f32 v132, v136, v137
  v_exp_f32 v140, v140
  s_waitcnt lgkmcnt(6)
  v_mfma_f32_32x32x16_bf16 v[200:215], v[196:199], v[28:31], v[200:215]
  ds_read_b64_tr_b16 v[188:189], v248 offset:62464
  ds_read_b64_tr_b16 v[190:191], v248 offset:62976
  v_exp_f32 v141, v141
  v_add_f32 v249, v249, v138
  v_add_f32 v250, v250, v139
  v_cvt_pk_bf16_f32 v133, v138, v139
  s_waitcnt lgkmcnt(6)
  v_mfma_f32_32x32x16_bf16 v[200:215], v[176:179], v[32:35], v[200:215]
  ds_read_b64_tr_b16 v[192:193], v248 offset:63488
  ds_read_b64_tr_b16 v[194:195], v248 offset:64000
  v_exp_f32 v142, v142
  v_exp_f32 v143, v143
  v_add_f32 v249, v249, v140
  v_add_f32 v250, v250, v141
  s_add_u32 m0, s55, 131072
  s_xor_b32 s64, s60, 36864
  buffer_load_dwordx4 v251, s[24:27], s64 offen offset:1024 sc1 lds
  s_waitcnt lgkmcnt(6)
  v_mfma_f32_32x32x16_bf16 v[200:215], v[180:183], v[36:39], v[200:215]
  ds_read_b64_tr_b16 v[196:197], v248 offset:64512
  ds_read_b64_tr_b16 v[198:199], v248 offset:65024
  v_cvt_pk_bf16_f32 v134, v140, v141
  v_add_f32 v249, v249, v142
  v_add_f32 v250, v250, v143
  v_cvt_pk_bf16_f32 v135, v142, v143
  s_waitcnt lgkmcnt(6)
  v_mfma_f32_32x32x16_bf16 v[216:231], v[184:187], v[112:115], v[216:231]
  ds_read_b64_tr_b16 v[176:177], v248 offset:10240
  ds_read_b64_tr_b16 v[178:179], v248 offset:10752
  s_waitcnt lgkmcnt(6)
  v_mfma_f32_32x32x16_bf16 v[216:231], v[188:191], v[116:119], v[216:231]
  ds_read_b64_tr_b16 v[180:181], v248 offset:11264
  ds_read_b64_tr_b16 v[182:183], v248 offset:11776
  v_add_f32 v250, v249, v250
  v_mov_b32 v249, v250
  v_mov_b32 v253, 0
  s_mov_b32 s65, 1568669696
  v_permlane32_swap_b32 v250, v249
  v_add_f32 v250, v250, v249
  s_nop 0
  v_cmp_nge_f32 vcc, s65, v250
  v_rcp_f32 v250, v250
  s_cmp_lg_u64 vcc, 0
  s_cbranch_scc1 L_fallback
L_join:
  s_waitcnt lgkmcnt(6)
  v_mfma_f32_32x32x16_bf16 v[216:231], v[192:195], v[128:131], v[216:231]
  ds_read_b64_tr_b16 v[184:185], v248 offset:12288
  ds_read_b64_tr_b16 v[186:187], v248 offset:12800
  s_add_u32 s64, s60, 2048
  buffer_load_dwordx4 v[144:147], v251, s[24:27], s64 offen offset:0 sc1
  s_waitcnt vmcnt(10)
  v_lshlrev_b32 v160, 16, v240
  v_and_b32 v161, 0xffff0000, v240
  v_lshlrev_b32 v162, 16, v241
  v_and_b32 v163, 0xffff0000, v241
  v_lshlrev_b32 v164, 16, v242
  s_waitcnt lgkmcnt(6)
  v_mfma_f32_32x32x16_bf16 v[216:231], v[196:199], v[132:135], v[216:231]
  ds_read_b64_tr_b16 v[188:189], v248 offset:13312
  ds_read_b64_tr_b16 v[190:191], v248 offset:13824
  v_and_b32 v165, 0xffff0000, v242
  v_lshlrev_b32 v166, 16, v243
  v_and_b32 v167, 0xffff0000, v243
  v_lshlrev_b32 v168, 16, v244
  v_and_b32 v169, 0xffff0000, v244
  s_waitcnt lgkmcnt(6)
  v_mfma_f32_32x32x16_bf16 v[200:215], v[176:179], v[40:43], v[200:215]
  ds_read_b64_tr_b16 v[192:193], v248 offset:14336
  ds_read_b64_tr_b16 v[194:195], v248 offset:14848
  s_add_u32 s64, s60, 2048
  buffer_load_dwordx4 v[148:151], v251, s[24:27], s64 offen offset:1024 sc1
  v_lshlrev_b32 v170, 16, v245
  v_and_b32 v171, 0xffff0000, v245
  v_lshlrev_b32 v172, 16, v246
  v_and_b32 v173, 0xffff0000, v246
  v_lshlrev_b32 v174, 16, v247
  v_and_b32 v175, 0xffff0000, v247
  s_waitcnt lgkmcnt(6)
  v_mfma_f32_32x32x16_bf16 v[200:215], v[180:183], v[44:47], v[200:215]
  ds_read_b64_tr_b16 v[196:197], v248 offset:15360
  ds_read_b64_tr_b16 v[198:199], v248 offset:15872
  v_mul_f32 v160, v160, v254
  v_mul_f32 v161, v161, v254
  v_mul_f32 v162, v162, v254
  v_mul_f32 v163, v163, v254
  v_mul_f32 v164, v164, v254
  s_waitcnt lgkmcnt(6)
  v_mfma_f32_32x32x16_bf16 v[200:215], v[184:187], v[48:51], v[200:215]
  ds_read_b64_tr_b16 v[176:177], v248 offset:16384
  ds_read_b64_tr_b16 v[178:179], v248 offset:16896
  s_add_u32 s64, s60, 4096
  buffer_load_dwordx4 v[152:155], v251, s[24:27], s64 offen offset:0 sc1
  v_mul_f32 v165, v165, v254
  v_mul_f32 v166, v166, v254
  v_mul_f32 v167, v167, v254
  v_mul_f32 v168, v168, v254
  v_mul_f32 v169, v169, v254
  v_mul_f32 v170, v170, v254
  s_waitcnt lgkmcnt(6)
  v_mfma_f32_32x32x16_bf16 v[200:215], v[188:191], v[52:55], v[200:215]
  ds_read_b64_tr_b16 v[180:181], v248 offset:17408
  ds_read_b64_tr_b16 v[182:183], v248 offset:17920
  v_lshlrev_b32 v249, 4, v255
  s_add_u32 s66, s81, 0
  v_mul_f32 v216, v216, v250
  v_mul_f32 v217, v217, v250
  v_cvt_pk_bf16_f32 v216, v216, v217
  v_mul_f32 v218, v218, v250
  v_mul_f32 v171, v171, v254
  v_mul_f32 v172, v172, v254
  v_mul_f32 v173, v173, v254
  v_mul_f32 v174, v174, v254
  v_mul_f32 v175, v175, v254
  s_waitcnt lgkmcnt(6)
  v_mfma_f32_32x32x16_bf16 v[200:215], v[192:195], v[56:59], v[200:215]
  ds_read_b64_tr_b16 v[184:185], v248 offset:18432
  ds_read_b64_tr_b16 v[186:187], v248 offset:18944
  v_mul_f32 v219, v219, v250
  v_cvt_pk_bf16_f32 v217, v218, v219
  v_mul_f32 v220, v220, v250
  v_mul_f32 v221, v221, v250
  v_cvt_pk_bf16_f32 v218, v220, v221
  v_mul_f32 v222, v222, v250
  s_add_u32 s64, s60, 4096
  buffer_load_dwordx4 v[156:159], v251, s[24:27], s64 offen offset:1024 sc1
  s_waitcnt lgkmcnt(6)
  v_mfma_f32_32x32x16_bf16 v[200:215], v[196:199], v[60:63], v[200:215]
  ds_read_b64_tr_b16 v[188:189], v248 offset:19456
  ds_read_b64_tr_b16 v[190:191], v248 offset:19968
  v_mul_f32 v223, v223, v250
  v_cvt_pk_bf16_f32 v219, v222, v223
  buffer_store_dwordx4 v[216:219], v249, s[24:27], s66 offen offset:0 sc1
  v_mul_f32 v224, v224, v250
  v_mul_f32 v225, v225, v250
  s_waitcnt lgkmcnt(6)
  v_mfma_f32_32x32x16_bf16 v[200:215], v[176:179], v[64:67], v[200:215]
  ds_read_b64_tr_b16 v[192:193], v248 offset:20480
  ds_read_b64_tr_b16 v[194:195], v248 offset:20992
  v_cvt_pk_bf16_f32 v220, v224, v225
  v_mul_f32 v226, v226, v250
  v_mul_f32 v227, v227, v250
  v_cvt_pk_bf16_f32 v221, v226, v227
  v_mul_f32 v228, v228, v250
  v_mul_f32 v229, v229, v250
  s_waitcnt lgkmcnt(6)
  v_mfma_f32_32x32x16_bf16 v[200:215], v[180:183], v[68:71], v[200:215]
  ds_read_b64_tr_b16 v[196:197], v248 offset:21504
  ds_read_b64_tr_b16 v[198:199], v248 offset:22016
  v_cvt_pk_bf16_f32 v222, v228, v229
  v_mul_f32 v230, v230, v250
  v_mul_f32 v231, v231, v250
  v_cvt_pk_bf16_f32 v223, v230, v231
  buffer_store_dwordx4 v[220:223], v249, s[24:27], s66 offen offset:1024 sc1
  s_add_u32 s64, s60, 6144
  buffer_load_dwordx4 v[136:139], v251, s[24:27], s64 offen offset:0 sc1
  v_permlane32_swap_b32 v160, v168
  v_permlane32_swap_b32 v161, v169
  v_permlane32_swap_b32 v162, v170
  v_permlane32_swap_b32 v163, v171
  v_permlane32_swap_b32 v164, v172
  s_waitcnt lgkmcnt(6)
  v_mfma_f32_32x32x16_bf16 v[200:215], v[184:187], v[72:75], v[200:215]
  ds_read_b64_tr_b16 v[176:177], v248 offset:22528
  ds_read_b64_tr_b16 v[178:179], v248 offset:23040
  v_permlane32_swap_b32 v165, v173
  v_permlane32_swap_b32 v166, v174
  v_permlane32_swap_b32 v167, v175
  v_add_f32 v160, v160, v168
  v_add_f32 v161, v161, v169
  s_waitcnt lgkmcnt(6)
  v_mfma_f32_32x32x16_bf16 v[200:215], v[188:191], v[76:79], v[200:215]
  ds_read_b64_tr_b16 v[180:181], v248 offset:23552
  ds_read_b64_tr_b16 v[182:183], v248 offset:24064
  s_add_u32 s64, s60, 6144
  buffer_load_dwordx4 v[140:143], v251, s[24:27], s64 offen offset:1024 sc1
  v_add_f32 v162, v162, v170
  v_add_f32 v163, v163, v171
  v_add_f32 v164, v164, v172
  v_add_f32 v165, v165, v173
  v_add_f32 v166, v166, v174
  s_waitcnt lgkmcnt(6)
  v_mfma_f32_32x32x16_bf16 v[200:215], v[192:195], v[80:83], v[200:215]
  ds_read_b64_tr_b16 v[184:185], v248 offset:24576
  ds_read_b64_tr_b16 v[186:187], v248 offset:25088
  v_add_f32 v167, v167, v175
  v_permlane16_swap_b32 v160, v164
  v_permlane16_swap_b32 v161, v165
  v_permlane16_swap_b32 v162, v166
  v_permlane16_swap_b32 v163, v167
  s_waitcnt lgkmcnt(6)
  v_mfma_f32_32x32x16_bf16 v[200:215], v[196:199], v[84:87], v[200:215]
  ds_read_b64_tr_b16 v[188:189], v248 offset:25600
  ds_read_b64_tr_b16 v[190:191], v248 offset:26112
  s_add_u32 s64, s60, 8192
  buffer_load_dwordx4 v[120:123], v251, s[24:27], s64 offen offset:0 sc1
  v_add_f32 v160, v160, v164
  v_add_f32 v161, v161, v165
  v_add_f32 v162, v162, v166
  v_add_f32 v163, v163, v167
  v_and_b32 v240, 7, v255
  s_waitcnt lgkmcnt(6)
  v_mfma_f32_32x32x16_bf16 v[200:215], v[176:179], v[88:91], v[200:215]
  ds_read_b64_tr_b16 v[192:193], v248 offset:26624
  ds_read_b64_tr_b16 v[194:195], v248 offset:27136
  v_lshrrev_b32 v241, 4, v255
  v_add_f32_dpp v160, v160, v160 row_ror:8 row_mask:0xf bank_mask:0xf
  v_add_f32_dpp v161, v161, v161 row_ror:8 row_mask:0xf bank_mask:0xf
  v_add_f32_dpp v162, v162, v162 row_ror:8 row_mask:0xf bank_mask:0xf
  v_add_f32_dpp v163, v163, v163 row_ror:8 row_mask:0xf bank_mask:0xf
  s_waitcnt lgkmcnt(6)
  v_mfma_f32_32x32x16_bf16 v[200:215], v[180:183], v[92:95], v[200:215]
  ds_read_b64_tr_b16 v[196:197], v248 offset:27648
  ds_read_b64_tr_b16 v[198:199], v248 offset:28160
  s_add_u32 s64, s60, 8192
  buffer_load_dwordx4 v[124:127], v251, s[24:27], s64 offen offset:1024 sc1
  v_lshlrev_b32 v241, 4, v241
  v_lshl_add_u32 v240, v240, 6, v241
  s_add_u32 s65, s55, 133120
  v_add_u32 v240, s65, v240
  ds_write_b128 v240, v[160:163]
  s_waitcnt lgkmcnt(7)
  v_mfma_f32_32x32x16_bf16 v[200:215], v[184:187], v[96:99], v[200:215]
  ds_read_b64_tr_b16 v[176:177], v248 offset:28672
  ds_read_b64_tr_b16 v[178:179], v248 offset:29184
  s_waitcnt lgkmcnt(7)
  v_mfma_f32_32x32x16_bf16 v[200:215], v[188:191], v[100:103], v[200:215]
  ds_read_b64_tr_b16 v[180:181], v248 offset:29696
  ds_read_b64_tr_b16 v[182:183], v248 offset:30208
  v_lshrrev_b32 v240, 3, v255
  v_and_b32 v241, 7, v255
  v_lshlrev_b32 v241, 4, v241
  v_lshl_add_u32 v240, v240, 10, v241
  s_min_u32 s65, s73, 171
  s_lshl_b32 s65, s65, 13
  s_lshl_b32 s64, s52, 7
  s_add_u32 s65, s65, s64
  buffer_load_dwordx4 v[244:247], v240, s[48:51], s65 offen
  s_waitcnt lgkmcnt(7)
  v_mfma_f32_32x32x16_bf16 v[200:215], v[192:195], v[104:107], v[200:215]
  ds_read_b64_tr_b16 v[184:185], v248 offset:30720
  ds_read_b64_tr_b16 v[186:187], v248 offset:31232
  s_add_u32 s64, s60, 12288
  buffer_load_dwordx4 v[160:163], v251, s[24:27], s64 offen offset:0 sc1
  s_waitcnt lgkmcnt(7)
  v_mfma_f32_32x32x16_bf16 v[200:215], v[196:199], v[108:111], v[200:215]
  ds_read_b64_tr_b16 v[188:189], v248 offset:31744
  ds_read_b64_tr_b16 v[190:191], v248 offset:32256
  s_waitcnt lgkmcnt(6)
  v_mfma_f32_32x32x16_bf16 v[200:215], v[176:179], v[112:115], v[200:215]
  s_waitcnt lgkmcnt(4)
  v_mfma_f32_32x32x16_bf16 v[200:215], v[180:183], v[116:119], v[200:215]
  v_add_u32 v248, 65536, v248
  s_waitcnt vmcnt(20)
  s_waitcnt lgkmcnt(0)
  s_barrier
  ds_read_b64_tr_b16 v[192:193], v248 offset:0
  ds_read_b64_tr_b16 v[194:195], v248 offset:512
  ds_read_b64_tr_b16 v[196:197], v248 offset:1024
  ds_read_b64_tr_b16 v[198:199], v248 offset:1536
  s_add_u32 s64, s60, 12288
  buffer_load_dwordx4 v[164:167], v251, s[24:27], s64 offen offset:1024 sc1
  v_mfma_f32_32x32x16_bf16 v[200:215], v[184:187], v[128:131], v[200:215]
  ds_read_b64_tr_b16 v[176:177], v248 offset:2048
  ds_read_b64_tr_b16 v[178:179], v248 offset:2560
  v_mfma_f32_32x32x16_bf16 v[200:215], v[188:191], v[132:135], v[200:215]
  ds_read_b64_tr_b16 v[180:181], v248 offset:3072
  ds_read_b64_tr_b16 v[182:183], v248 offset:3584
  v_lshrrev_b32 v240, 4, v255
  v_and_b32 v241, 15, v255
  v_lshlrev_b32 v241, 2, v241
  v_lshl_add_u32 v240, v240, 12, v241
  s_lshl_b32 s65, s52, 6
  s_add_u32 s65, s65, 133120
  v_add_u32 v240, s65, v240
  ds_read_b32 v242, v240
  ds_read_b32 v243, v240 offset:16384
  s_waitcnt lgkmcnt(8)
  v_mfma_f32_32x32x16_bf16 v[216:231], v[192:195], v[0:3], 0
  ds_read_b64_tr_b16 v[184:185], v248 offset:4096
  ds_read_b64_tr_b16 v[186:187], v248 offset:4608
  s_waitcnt lgkmcnt(8)
  v_mfma_f32_32x32x16_bf16 v[216:231], v[196:199], v[4:7], v[216:231]
  ds_read_b64_tr_b16 v[188:189], v248 offset:5120
  ds_read_b64_tr_b16 v[190:191], v248 offset:5632
  s_add_u32 s64, s60, 14336
  buffer_load_dwordx4 v[168:171], v251, s[24:27], s64 offen offset:0 sc1
  s_waitcnt lgkmcnt(4)
  v_add_f32 v242, v242, v243
  v_mov_b32 v243, v242
  s_nop 1
  v_mfma_f32_32x32x16_bf16 v[216:231], v[176:179], v[8:11], v[216:231]
  ds_read_b64_tr_b16 v[192:193], v248 offset:6144
  ds_read_b64_tr_b16 v[194:195], v248 offset:6656
  v_permlane32_swap_b32 v242, v243
  v_add_f32 v242, v242, v243
  v_mov_b32 v243, v242
  v_mfma_f32_32x32x16_bf16 v[216:231], v[180:183], v[12:15], v[216:231]
  ds_read_b64_tr_b16 v[196:197], v248 offset:7168
  ds_read_b64_tr_b16 v[198:199], v248 offset:7680
  v_lshlrev_b32 v249, 4, v255
  s_add_u32 s66, s81, 4194304
  v_mul_f32 v200, v200, v250
  v_mul_f32 v201, v201, v250
  v_cvt_pk_bf16_f32 v200, v200, v201
  v_mul_f32 v202, v202, v250
  s_nop 1
  v_permlane16_swap_b32 v242, v243
  v_add_f32 v242, v242, v243
  s_waitcnt lgkmcnt(6)
  v_mfma_f32_32x32x16_bf16 v[216:231], v[184:187], v[16:19], v[216:231]
  ds_read_b64_tr_b16 v[176:177], v248 offset:8192
  ds_read_b64_tr_b16 v[178:179], v248 offset:8704
  v_mul_f32 v203, v203, v250
  v_cvt_pk_bf16_f32 v201, v202, v203
  v_mul_f32 v204, v204, v250
  v_mul_f32 v205, v205, v250
  v_cvt_pk_bf16_f32 v202, v204, v205
  v_mul_f32 v206, v206, v250
  s_add_u32 s64, s60, 14336
  buffer_load_dwordx4 v[172:175], v251, s[24:27], s64 offen offset:1024 sc1
  s_andn2_b32 s65, s73, 7
  s_add_u32 s65, s65, s52
  s_lshl_b32 s68, s65, 7
  s_add_u32 s68, s68, 65536
  s_lshl_b32 s65, s65, 9
  s_and_b32 s64, s73, 7
  s_lshl_b32 s64, s64, 6
  s_add_u32 s65, s65, s64
  s_add_u32 s65, s65, 17268736
  s_cmp_lt_u32 s73, 176
  s_cselect_b32 s65, s65, 0x7f000000
  s_mov_b64 exec, 0xffff
  buffer_store_dword v242, v241, s[24:27], s65 offen sc1
  s_mov_b64 exec, -1
  s_waitcnt lgkmcnt(6)
  v_mfma_f32_32x32x16_bf16 v[216:231], v[188:191], v[20:23], v[216:231]
  ds_read_b64_tr_b16 v[180:181], v248 offset:9216
  ds_read_b64_tr_b16 v[182:183], v248 offset:9728
  v_mul_f32 v207, v207, v250
  v_cvt_pk_bf16_f32 v203, v206, v207
  buffer_store_dwordx4 v[200:203], v249, s[24:27], s66 offen offset:0 sc1
  v_mul_f32 v208, v208, v250
  v_mul_f32 v209, v209, v250
  s_waitcnt lgkmcnt(6)
  v_mfma_f32_32x32x16_bf16 v[216:231], v[192:195], v[24:27], v[216:231]
  ds_read_b64_tr_b16 v[184:185], v248 offset:10240
  ds_read_b64_tr_b16 v[186:187], v248 offset:10752
  v_cvt_pk_bf16_f32 v204, v208, v209
  v_mul_f32 v210, v210, v250
  v_mul_f32 v211, v211, v250
  v_cvt_pk_bf16_f32 v205, v210, v211
  v_mul_f32 v212, v212, v250
  v_mul_f32 v213, v213, v250
  s_waitcnt lgkmcnt(6)
  v_mfma_f32_32x32x16_bf16 v[216:231], v[196:199], v[28:31], v[216:231]
  ds_read_b64_tr_b16 v[188:189], v248 offset:11264
  ds_read_b64_tr_b16 v[190:191], v248 offset:11776
  v_cvt_pk_bf16_f32 v206, v212, v213
  v_mul_f32 v214, v214, v250
  v_mul_f32 v215, v215, v250
  v_cvt_pk_bf16_f32 v207, v214, v215
  buffer_store_dwordx4 v[204:207], v249, s[24:27], s66 offen offset:1024 sc1
  s_waitcnt lgkmcnt(6)
  v_mfma_f32_32x32x16_bf16 v[216:231], v[176:179], v[32:35], v[216:231]
  ds_read_b64_tr_b16 v[192:193], v248 offset:12288
  ds_read_b64_tr_b16 v[194:195], v248 offset:12800
  s_add_u32 m0, s55, 0
  s_xor_b32 s64, s60, 38912
  buffer_load_dwordx4 v251, s[24:27], s64 offen offset:0 sc1 lds
  s_waitcnt lgkmcnt(6)
  v_mfma_f32_32x32x16_bf16 v[216:231], v[180:183], v[36:39], v[216:231]
  ds_read_b64_tr_b16 v[196:197], v248 offset:13312
  ds_read_b64_tr_b16 v[198:199], v248 offset:13824
  s_waitcnt lgkmcnt(6)
  v_mfma_f32_32x32x16_bf16 v[216:231], v[184:187], v[40:43], v[216:231]
  ds_read_b64_tr_b16 v[176:177], v248 offset:14336
  ds_read_b64_tr_b16 v[178:179], v248 offset:14848
  s_add_u32 m0, s55, 0
  s_xor_b32 s64, s60, 38912
  buffer_load_dwordx4 v251, s[24:27], s64 offen offset:1024 sc1 lds
  s_waitcnt lgkmcnt(6)
  v_mfma_f32_32x32x16_bf16 v[216:231], v[188:191], v[44:47], v[216:231]
  ds_read_b64_tr_b16 v[180:181], v248 offset:15360
  ds_read_b64_tr_b16 v[182:183], v248 offset:15872
  s_waitcnt lgkmcnt(6)
  v_mfma_f32_32x32x16_bf16 v[216:231], v[192:195], v[48:51], v[216:231]
  ds_read_b64_tr_b16 v[184:185], v248 offset:16384
  ds_read_b64_tr_b16 v[186:187], v248 offset:16896
  s_waitcnt vmcnt(14)
  s_mov_b32 s96, 1
  s_atomic_add s96, s[98:99], s74
  s_waitcnt lgkmcnt(6)
  v_mfma_f32_32x32x16_bf16 v[216:231], v[196:199], v[52:55], v[216:231]
  ds_read_b64_tr_b16 v[188:189], v248 offset:17408
  ds_read_b64_tr_b16 v[190:191], v248 offset:17920
  s_add_u32 m0, s55, 2048
  s_xor_b32 s64, s60, 43008
  buffer_load_dwordx4 v251, s[24:27], s64 offen offset:0 sc1 lds
  s_waitcnt lgkmcnt(6)
  v_mfma_f32_32x32x16_bf16 v[216:231], v[176:179], v[56:59], v[216:231]
  ds_read_b64_tr_b16 v[192:193], v248 offset:18432
  ds_read_b64_tr_b16 v[194:195], v248 offset:18944
  s_waitcnt lgkmcnt(6)
  v_mfma_f32_32x32x16_bf16 v[216:231], v[180:183], v[60:63], v[216:231]
  ds_read_b64_tr_b16 v[196:197], v248 offset:19456
  ds_read_b64_tr_b16 v[198:199], v248 offset:19968
  s_waitcnt lgkmcnt(6)
  v_mfma_f32_32x32x16_bf16 v[216:231], v[184:187], v[64:67], v[216:231]
  ds_read_b64_tr_b16 v[176:177], v248 offset:20480
  ds_read_b64_tr_b16 v[178:179], v248 offset:20992
  s_add_u32 m0, s55, 2048
  s_xor_b32 s64, s60, 43008
  buffer_load_dwordx4 v251, s[24:27], s64 offen offset:1024 sc1 lds
  s_waitcnt lgkmcnt(6)
  v_mfma_f32_32x32x16_bf16 v[216:231], v[188:191], v[68:71], v[216:231]
  ds_read_b64_tr_b16 v[180:181], v248 offset:21504
  ds_read_b64_tr_b16 v[182:183], v248 offset:22016
  s_waitcnt lgkmcnt(6)
  v_mfma_f32_32x32x16_bf16 v[216:231], v[192:195], v[72:75], v[216:231]
  ds_read_b64_tr_b16 v[184:185], v248 offset:22528
  ds_read_b64_tr_b16 v[186:187], v248 offset:23040
  s_waitcnt lgkmcnt(6)
  v_mfma_f32_32x32x16_bf16 v[216:231], v[196:199], v[76:79], v[216:231]
  ds_read_b64_tr_b16 v[188:189], v248 offset:23552
  ds_read_b64_tr_b16 v[190:191], v248 offset:24064
  s_add_u32 m0, s55, 32768
  s_xor_b32 s64, s60, 45056
  buffer_load_dwordx4 v251, s[24:27], s64 offen offset:0 sc1 lds
  s_waitcnt lgkmcnt(6)
  v_mfma_f32_32x32x16_bf16 v[216:231], v[176:179], v[80:83], v[216:231]
  ds_read_b64_tr_b16 v[192:193], v248 offset:24576
  ds_read_b64_tr_b16 v[194:195], v248 offset:25088
  s_waitcnt lgkmcnt(6)
  v_mfma_f32_32x32x16_bf16 v[216:231], v[180:183], v[84:87], v[216:231]
  ds_read_b64_tr_b16 v[196:197], v248 offset:25600
  ds_read_b64_tr_b16 v[198:199], v248 offset:26112
  s_waitcnt lgkmcnt(6)
  v_mfma_f32_32x32x16_bf16 v[216:231], v[184:187], v[88:91], v[216:231]
  ds_read_b64_tr_b16 v[176:177], v248 offset:26624
  ds_read_b64_tr_b16 v[178:179], v248 offset:27136
  s_add_u32 m0, s55, 32768
  s_xor_b32 s64, s60, 45056
  buffer_load_dwordx4 v251, s[24:27], s64 offen offset:1024 sc1 lds
  s_waitcnt lgkmcnt(6)
  v_mfma_f32_32x32x16_bf16 v[216:231], v[188:191], v[92:95], v[216:231]
  ds_read_b64_tr_b16 v[180:181], v248 offset:27648
  ds_read_b64_tr_b16 v[182:183], v248 offset:28160
  s_waitcnt lgkmcnt(6)
  v_mfma_f32_32x32x16_bf16 v[216:231], v[192:195], v[96:99], v[216:231]
  ds_read_b64_tr_b16 v[184:185], v248 offset:28672
  ds_read_b64_tr_b16 v[186:187], v248 offset:29184
  s_waitcnt lgkmcnt(6)
  v_mfma_f32_32x32x16_bf16 v[216:231], v[196:199], v[100:103], v[216:231]
  ds_read_b64_tr_b16 v[188:189], v248 offset:29696
  ds_read_b64_tr_b16 v[190:191], v248 offset:30208
  s_add_u32 m0, s55, 34816
  s_xor_b32 s64, s60, 49152
  buffer_load_dwordx4 v251, s[24:27], s64 offen offset:0 sc1 lds
  s_waitcnt lgkmcnt(6)
  v_mfma_f32_32x32x16_bf16 v[216:231], v[176:179], v[104:107], v[216:231]
  ds_read_b64_tr_b16 v[192:193], v248 offset:30720
  ds_read_b64_tr_b16 v[194:195], v248 offset:31232
  s_waitcnt lgkmcnt(6)
  v_mfma_f32_32x32x16_bf16 v[216:231], v[180:183], v[108:111], v[216:231]
  ds_read_b64_tr_b16 v[196:197], v248 offset:31744
  ds_read_b64_tr_b16 v[198:199], v248 offset:32256
  s_waitcnt lgkmcnt(6)
  v_mfma_f32_32x32x16_bf16 v[216:231], v[184:187], v[112:115], v[216:231]
  s_add_u32 m0, s55, 34816
  s_xor_b32 s64, s60, 49152
  buffer_load_dwordx4 v251, s[24:27], s64 offen offset:1024 sc1 lds
  s_waitcnt lgkmcnt(4)
  v_mfma_f32_32x32x16_bf16 v[216:231], v[188:191], v[116:119], v[216:231]
  s_waitcnt lgkmcnt(0)
  s_barrier
  ds_read_b64_tr_b16 v[176:177], v248 offset:32768
  ds_read_b64_tr_b16 v[178:179], v248 offset:33280
  ds_read_b64_tr_b16 v[180:181], v248 offset:33792
  ds_read_b64_tr_b16 v[182:183], v248 offset:34304
  v_mfma_f32_32x32x16_bf16 v[216:231], v[192:195], v[128:131], v[216:231]
  ds_read_b64_tr_b16 v[184:185], v248 offset:34816
  ds_read_b64_tr_b16 v[186:187], v248 offset:35328
  s_cmp_ge_u32 s73, 176
  s_cbranch_scc1 Ly_9
  s_waitcnt vmcnt(10)
  s_mov_b32 s67, 1
  s_atomic_add s67, s[98:99], s68
Ly_9:
  v_mfma_f32_32x32x16_bf16 v[216:231], v[196:199], v[132:135], v[216:231]
  ds_read_b64_tr_b16 v[188:189], v248 offset:35840
  ds_read_b64_tr_b16 v[190:191], v248 offset:36352
  s_waitcnt lgkmcnt(6)
  v_mfma_f32_32x32x16_bf16 v[200:215], v[176:179], v[0:3], 0
  ds_read_b64_tr_b16 v[192:193], v248 offset:36864
  ds_read_b64_tr_b16 v[194:195], v248 offset:37376
  s_waitcnt lgkmcnt(6)
  v_mfma_f32_32x32x16_bf16 v[200:215], v[180:183], v[4:7], v[200:215]
  ds_read_b64_tr_b16 v[196:197], v248 offset:37888
  ds_read_b64_tr_b16 v[198:199], v248 offset:38400
  s_waitcnt lgkmcnt(6)
  v_mfma_f32_32x32x16_bf16 v[200:215], v[184:187], v[8:11], v[200:215]
  ds_read_b64_tr_b16 v[176:177], v248 offset:38912
  ds_read_b64_tr_b16 v[178:179], v248 offset:39424
  s_waitcnt vmcnt(8)
  s_mov_b32 s96, 256
  s_atomic_add s96, s[98:99], s74
  s_waitcnt lgkmcnt(6)
  v_mfma_f32_32x32x16_bf16 v[200:215], v[188:191], v[12:15], v[200:215]
  ds_read_b64_tr_b16 v[180:181], v248 offset:39936
  ds_read_b64_tr_b16 v[182:183], v248 offset:40448
  v_lshlrev_b32 v249, 4, v255
  s_add_u32 s66, s81, 8388608
  v_mul_f32 v216, v216, v250
  v_mul_f32 v217, v217, v250
  v_cvt_pk_bf16_f32 v216, v216, v217
  v_mul_f32 v218, v218, v250
  s_waitcnt lgkmcnt(6)
  v_mfma_f32_32x32x16_bf16 v[200:215], v[192:195], v[16:19], v[200:215]
  ds_read_b64_tr_b16 v[184:185], v248 offset:40960
  ds_read_b64_tr_b16 v[186:187], v248 offset:41472
  v_mul_f32 v219, v219, v250
  v_cvt_pk_bf16_f32 v217, v218, v219
  v_mul_f32 v220, v220, v250
  v_mul_f32 v221, v221, v250
  v_cvt_pk_bf16_f32 v218, v220, v221
  v_mul_f32 v222, v222, v250
  s_add_u32 s64, s60, 18432
  buffer_load_dwordx4 v[0:3], v251, s[24:27], s64 offen offset:0 sc1
  s_waitcnt lgkmcnt(6)
  v_mfma_f32_32x32x16_bf16 v[200:215], v[196:199], v[20:23], v[200:215]
  ds_read_b64_tr_b16 v[188:189], v248 offset:41984
  ds_read_b64_tr_b16 v[190:191], v248 offset:42496
  v_mul_f32 v223, v223, v250
  v_cvt_pk_bf16_f32 v219, v222, v223
  buffer_store_dwordx4 v[216:219], v249, s[24:27], s66 offen offset:0 sc1
  v_mul_f32 v224, v224, v250
  v_mul_f32 v225, v225, v250
  s_add_u32 s64, s60, 18432
  buffer_load_dwordx4 v[4:7], v251, s[24:27], s64 offen offset:1024 sc1
  s_waitcnt lgkmcnt(6)
  v_mfma_f32_32x32x16_bf16 v[200:215], v[176:179], v[24:27], v[200:215]
  ds_read_b64_tr_b16 v[192:193], v248 offset:43008
  ds_read_b64_tr_b16 v[194:195], v248 offset:43520
  v_cvt_pk_bf16_f32 v220, v224, v225
  v_mul_f32 v226, v226, v250
  v_mul_f32 v227, v227, v250
  v_cvt_pk_bf16_f32 v221, v226, v227
  v_mul_f32 v228, v228, v250
  v_mul_f32 v229, v229, v250
  s_add_u32 s64, s60, 20480
  buffer_load_dwordx4 v[8:11], v251, s[24:27], s64 offen offset:0 sc1
  s_waitcnt lgkmcnt(6)
  v_mfma_f32_32x32x16_bf16 v[200:215], v[180:183], v[28:31], v[200:215]
  ds_read_b64_tr_b16 v[196:197], v248 offset:44032
  ds_read_b64_tr_b16 v[198:199], v248 offset:44544
  v_cvt_pk_bf16_f32 v222, v228, v229
  v_mul_f32 v230, v230, v250
  v_mul_f32 v231, v231, v250
  v_cvt_pk_bf16_f32 v223, v230, v231
  buffer_store_dwordx4 v[220:223], v249, s[24:27], s66 offen offset:1024 sc1
  s_add_u32 s64, s60, 20480
  buffer_load_dwordx4 v[12:15], v251, s[24:27], s64 offen offset:1024 sc1
  s_waitcnt lgkmcnt(6)
  v_mfma_f32_32x32x16_bf16 v[200:215], v[184:187], v[32:35], v[200:215]
  ds_read_b64_tr_b16 v[176:177], v248 offset:45056
  ds_read_b64_tr_b16 v[178:179], v248 offset:45568
  s_add_u32 m0, s55, 65536
  s_xor_b32 s64, s60, 51200
  buffer_load_dwordx4 v251, s[24:27], s64 offen offset:0 sc1 lds
  s_waitcnt lgkmcnt(6)
  v_mfma_f32_32x32x16_bf16 v[200:215], v[188:191], v[36:39], v[200:215]
  ds_read_b64_tr_b16 v[180:181], v248 offset:46080
  ds_read_b64_tr_b16 v[182:183], v248 offset:46592
  s_add_u32 m0, s55, 65536
  s_xor_b32 s64, s60, 51200
  buffer_load_dwordx4 v251, s[24:27], s64 offen offset:1024 sc1 lds
  s_load_dword s97, s[98:99], s3 glc
  s_min_u32 s71, s73, 171
  s_lshl_b32 s71, s71, 7
  s_add_u32 s71, s71, 65536
  s_cmp_ge_u32 s73, 172
  s_cbranch_scc1 Ly_10
  s_load_dword s82, s[98:99], s71 glc
Ly_10:
  s_waitcnt lgkmcnt(6)
  v_mfma_f32_32x32x16_bf16 v[200:215], v[192:195], v[40:43], v[200:215]
  ds_read_b64_tr_b16 v[184:185], v248 offset:47104
  ds_read_b64_tr_b16 v[186:187], v248 offset:47616
  s_add_u32 s64, s60, 24576
  buffer_load_dwordx4 v[16:19], v251, s[24:27], s64 offen offset:0 sc1
  s_waitcnt lgkmcnt(6)
  v_mfma_f32_32x32x16_bf16 v[200:215], v[196:199], v[44:47], v[200:215]
  ds_read_b64_tr_b16 v[188:189], v248 offset:48128
  ds_read_b64_tr_b16 v[190:191], v248 offset:48640
  s_add_u32 s64, s60, 24576
  buffer_load_dwordx4 v[20:23], v251, s[24:27], s64 offen offset:1024 sc1
  s_waitcnt lgkmcnt(6)
  v_mfma_f32_32x32x16_bf16 v[200:215], v[176:179], v[48:51], v[200:215]
  ds_read_b64_tr_b16 v[192:193], v248 offset:49152
  ds_read_b64_tr_b16 v[194:195], v248 offset:49664
  s_add_u32 s64, s60, 26624
  buffer_load_dwordx4 v[24:27], v251, s[24:27], s64 offen offset:0 sc1
  s_waitcnt lgkmcnt(6)
  v_mfma_f32_32x32x16_bf16 v[200:215], v[180:183], v[52:55], v[200:215]
  ds_read_b64_tr_b16 v[196:197], v248 offset:50176
  ds_read_b64_tr_b16 v[198:199], v248 offset:50688
  s_add_u32 s64, s60, 26624
  buffer_load_dwordx4 v[28:31], v251, s[24:27], s64 offen offset:1024 sc1
  s_waitcnt lgkmcnt(6)
  v_mfma_f32_32x32x16_bf16 v[200:215], v[184:187], v[56:59], v[200:215]
  ds_read_b64_tr_b16 v[176:177], v248 offset:51200
  ds_read_b64_tr_b16 v[178:179], v248 offset:51712
  s_add_u32 s64, s60, 30720
  buffer_load_dwordx4 v[216:219], v251, s[24:27], s64 offen offset:0 sc1
  s_waitcnt lgkmcnt(6)
  v_mfma_f32_32x32x16_bf16 v[200:215], v[188:191], v[60:63], v[200:215]
  ds_read_b64_tr_b16 v[180:181], v248 offset:52224
  ds_read_b64_tr_b16 v[182:183], v248 offset:52736
  s_add_u32 s64, s60, 30720
  buffer_load_dwordx4 v[220:223], v251, s[24:27], s64 offen offset:1024 sc1
  s_waitcnt lgkmcnt(6)
  v_mfma_f32_32x32x16_bf16 v[200:215], v[192:195], v[64:67], v[200:215]
  ds_read_b64_tr_b16 v[184:185], v248 offset:53248
  ds_read_b64_tr_b16 v[186:187], v248 offset:53760
  s_add_u32 s64, s60, 32768
  buffer_load_dwordx4 v[224:227], v251, s[24:27], s64 offen offset:0 sc1
  s_waitcnt lgkmcnt(6)
  v_mfma_f32_32x32x16_bf16 v[200:215], v[196:199], v[68:71], v[200:215]
  ds_read_b64_tr_b16 v[188:189], v248 offset:54272
  ds_read_b64_tr_b16 v[190:191], v248 offset:54784
  s_add_u32 s64, s60, 32768
  buffer_load_dwordx4 v[228:231], v251, s[24:27], s64 offen offset:1024 sc1
  s_waitcnt lgkmcnt(6)
  v_mfma_f32_32x32x16_bf16 v[200:215], v[176:179], v[72:75], v[200:215]
  ds_read_b64_tr_b16 v[192:193], v248 offset:55296
  ds_read_b64_tr_b16 v[194:195], v248 offset:55808
  s_add_u32 m0, s55, 67584
  s_xor_b32 s64, s60, 55296
  buffer_load_dwordx4 v251, s[24:27], s64 offen offset:0 sc1 lds
  s_waitcnt lgkmcnt(0)
  s_mov_b32 s80, 0
Lspin_11:
  s_bfe_u32 s65, s97, 0x80000
  s_cmp_eq_u32 s65, 8
  s_cbranch_scc1 Lok_12
  s_sleep 4
  s_load_dword s97, s[98:99], s3 glc
  s_waitcnt lgkmcnt(0)
  s_add_u32 s80, s80, 1
  s_cmp_lt_u32 s80, 0x80000
  s_cbranch_scc1 Lspin_11
Lok_12:
  s_cmp_ge_u32 s73, 172
  s_cbranch_scc1 Ly_13
  s_waitcnt lgkmcnt(0)
  s_mov_b32 s80, 0
Lspin_14:
  s_bfe_u32 s65, s82, 0x80000
  s_cmp_eq_u32 s65, 8
  s_cbranch_scc1 Lok_15
  s_sleep 4
  s_load_dword s82, s[98:99], s71 glc
  s_waitcnt lgkmcnt(0)
  s_add_u32 s80, s80, 1
  s_cmp_lt_u32 s80, 0x80000
  s_cbranch_scc1 Lspin_14
Lok_15:
Ly_13:
  v_and_b32 v240, 7, v255
  v_lshrrev_b32 v241, 3, v255
  v_lshlrev_b32 v241, 2, v241
  v_lshl_add_u32 v240, v240, 6, v241
  s_sub_u32 s65, s71, 65536
  s_lshl_b32 s65, s65, 2
  s_add_u32 s65, s65, 17268736
  buffer_load_dword v242, v240, s[24:27], s65 offen sc1
  buffer_load_dword v243, v240, s[24:27], s65 offen offset:32 sc1
  s_load_dword s97, s[98:99], s3 glc
  v_mfma_f32_32x32x16_bf16 v[200:215], v[180:183], v[76:79], v[200:215]
  ds_read_b64_tr_b16 v[196:197], v248 offset:56320
  ds_read_b64_tr_b16 v[198:199], v248 offset:56832
  s_add_u32 m0, s55, 67584
  s_xor_b32 s64, s60, 55296
  buffer_load_dwordx4 v251, s[24:27], s64 offen offset:1024 sc1 lds
  v_mfma_f32_32x32x16_bf16 v[200:215], v[184:187], v[80:83], v[200:215]
  ds_read_b64_tr_b16 v[176:177], v248 offset:57344
  ds_read_b64_tr_b16 v[178:179], v248 offset:57856
  v_mfma_f32_32x32x16_bf16 v[200:215], v[188:191], v[84:87], v[200:215]
  ds_read_b64_tr_b16 v[180:181], v248 offset:58368
  ds_read_b64_tr_b16 v[182:183], v248 offset:58880
  s_xor_b32 s64, s77, 0
  buffer_load_dwordx4 v[32:35], v251, s[24:27], s64 offen sc1
  s_xor_b32 s64, s78, 0
  buffer_load_dwordx4 v[36:39], v251, s[24:27], s64 offen sc1
  v_mfma_f32_32x32x16_bf16 v[200:215], v[192:195], v[88:91], v[200:215]
  ds_read_b64_tr_b16 v[184:185], v248 offset:59392
  ds_read_b64_tr_b16 v[186:187], v248 offset:59904
  s_waitcnt lgkmcnt(6)
  v_mfma_f32_32x32x16_bf16 v[200:215], v[196:199], v[92:95], v[200:215]
  ds_read_b64_tr_b16 v[188:189], v248 offset:60416
  ds_read_b64_tr_b16 v[190:191], v248 offset:60928
  s_xor_b32 s64, s77, 1024
  buffer_load_dwordx4 v[40:43], v251, s[24:27], s64 offen sc1
  s_xor_b32 s64, s78, 1024
  buffer_load_dwordx4 v[44:47], v251, s[24:27], s64 offen sc1
  s_waitcnt lgkmcnt(6)
  v_mfma_f32_32x32x16_bf16 v[200:215], v[176:179], v[96:99], v[200:215]
  ds_read_b64_tr_b16 v[192:193], v248 offset:61440
  ds_read_b64_tr_b16 v[194:195], v248 offset:61952
  s_waitcnt lgkmcnt(6)
  v_mfma_f32_32x32x16_bf16 v[200:215], v[180:183], v[100:103], v[200:215]
  ds_read_b64_tr_b16 v[196:197], v248 offset:62464
  ds_read_b64_tr_b16 v[198:199], v248 offset:62976
  s_xor_b32 s64, s77, 2048
  buffer_load_dwordx4 v[48:51], v251, s[24:27], s64 offen sc1
  s_xor_b32 s64, s78, 2048
  buffer_load_dwordx4 v[52:55], v251, s[24:27], s64 offen sc1
  s_waitcnt lgkmcnt(6)
  v_mfma_f32_32x32x16_bf16 v[200:215], v[184:187], v[104:107], v[200:215]
  ds_read_b64_tr_b16 v[176:177], v248 offset:63488
  ds_read_b64_tr_b16 v[178:179], v248 offset:64000
  s_waitcnt lgkmcnt(6)
  v_mfma_f32_32x32x16_bf16 v[200:215], v[188:191], v[108:111], v[200:215]
  ds_read_b64_tr_b16 v[180:181], v248 offset:64512
  ds_read_b64_tr_b16 v[182:183], v248 offset:65024
  s_xor_b32 s64, s77, 3072
  buffer_load_dwordx4 v[56:59], v251, s[24:27], s64 offen sc1
  s_xor_b32 s64, s78, 3072
  buffer_load_dwordx4 v[60:63], v251, s[24:27], s64 offen sc1
  s_waitcnt lgkmcnt(6)
  v_mfma_f32_32x32x16_bf16 v[200:215], v[192:195], v[112:115], v[200:215]
  s_waitcnt lgkmcnt(4)
  v_mfma_f32_32x32x16_bf16 v[200:215], v[196:199], v[116:119], v[200:215]
  s_waitcnt lgkmcnt(0)
  s_barrier
  v_mfma_f32_32x32x16_bf16 v[200:215], v[176:179], v[128:131], v[200:215]
  v_mfma_f32_32x32x16_bf16 v[200:215], v[180:183], v[132:135], v[200:215]
  s_setprio 2
  s_waitcnt vmcnt(23)
  s_mov_b32 s96, 65536
  s_atomic_add s96, s[98:99], s74
  s_nop 7
  v_lshlrev_b32 v249, 4, v255
  s_add_u32 s66, s81, 12582912
  v_mul_f32 v200, v200, v250
  v_mul_f32 v201, v201, v250
  v_cvt_pk_bf16_f32 v200, v200, v201
  v_mul_f32 v202, v202, v250
  v_mul_f32 v203, v203, v250
  v_cvt_pk_bf16_f32 v201, v202, v203
  v_mul_f32 v204, v204, v250
  v_mul_f32 v205, v205, v250
  v_cvt_pk_bf16_f32 v202, v204, v205
  v_mul_f32 v206, v206, v250
  v_mul_f32 v207, v207, v250
  v_cvt_pk_bf16_f32 v203, v206, v207
  buffer_store_dwordx4 v[200:203], v249, s[24:27], s66 offen offset:0 sc1
  v_mul_f32 v208, v208, v250
  v_mul_f32 v209, v209, v250
  v_cvt_pk_bf16_f32 v204, v208, v209
  v_mul_f32 v210, v210, v250
  v_mul_f32 v211, v211, v250
  v_cvt_pk_bf16_f32 v205, v210, v211
  v_mul_f32 v212, v212, v250
  v_mul_f32 v213, v213, v250
  v_cvt_pk_bf16_f32 v206, v212, v213
  v_mul_f32 v214, v214, v250
  v_mul_f32 v215, v215, v250
  v_cvt_pk_bf16_f32 v207, v214, v215
  buffer_store_dwordx4 v[204:207], v249, s[24:27], s66 offen offset:1024 sc1
  s_add_u32 s64, s57, 0
  buffer_load_dwordx4 v[128:131], v251, s[24:27], s64 offen offset:0 sc1
  s_add_u32 s64, s57, 0
  buffer_load_dwordx4 v[132:135], v251, s[24:27], s64 offen offset:1024 sc1
  s_add_u32 m0, s55, 98304
  s_xor_b32 s64, s60, 57344
  buffer_load_dwordx4 v251, s[24:27], s64 offen offset:0 sc1 lds
  s_add_u32 m0, s55, 98304
  s_xor_b32 s64, s60, 57344
  buffer_load_dwordx4 v251, s[24:27], s64 offen offset:1024 sc1 lds
  s_add_u32 m0, s55, 100352
  s_xor_b32 s64, s60, 61440
  buffer_load_dwordx4 v251, s[24:27], s64 offen offset:0 sc1 lds
  s_add_u32 m0, s55, 100352
  s_xor_b32 s64, s60, 61440
  buffer_load_dwordx4 v251, s[24:27], s64 offen offset:1024 sc1 lds
  s_waitcnt vmcnt(14)
  v_mfma_f32_32x32x16_bf16 v[64:79], v[232:235], v[32:35], 0
  v_mfma_f32_32x32x16_bf16 v[80:95], v[232:235], v[36:39], 0
  v_mfma_f32_32x32x16_bf16 v[96:111], v[236:239], v[32:35], 0
  v_mfma_f32_32x32x16_bf16 v[200:215], v[236:239], v[36:39], 0
  v_lshlrev_b32 v232, 16, v244
  v_and_b32 v233, 0xffff0000, v244
  v_add_f32_dpp v242, v242, v242 quad_perm:[1,0,3,2] row_mask:0xf bank_mask:0xf
  v_add_f32_dpp v243, v243, v243 quad_perm:[1,0,3,2] row_mask:0xf bank_mask:0xf
  v_lshlrev_b32 v234, 16, v245
  v_and_b32 v235, 0xffff0000, v245
  v_add_f32_dpp v242, v242, v242 quad_perm:[2,3,0,1] row_mask:0xf bank_mask:0xf
  v_add_f32_dpp v243, v243, v243 quad_perm:[2,3,0,1] row_mask:0xf bank_mask:0xf
  v_lshlrev_b32 v236, 16, v246
  v_and_b32 v237, 0xffff0000, v246
  v_add_f32_dpp v242, v242, v242 row_half_mirror row_mask:0xf bank_mask:0xf
  s_xor_b32 s64, s77, 4096
  buffer_load_dwordx4 v[32:35], v251, s[24:27], s64 offen sc1
  s_xor_b32 s64, s78, 4096
  buffer_load_dwordx4 v[36:39], v251, s[24:27], s64 offen sc1
  s_waitcnt vmcnt(14)
  v_mfma_f32_32x32x16_bf16 v[64:79], v[144:147], v[40:43], v[64:79]
  v_add_f32_dpp v243, v243, v243 row_half_mirror row_mask:0xf bank_mask:0xf
  v_lshlrev_b32 v238, 16, v247
  v_and_b32 v239, 0xffff0000, v247
  v_cvt_pk_bf16_f32 v242, v242, v242
  v_and_b32 v242, 0xffff0000, v242
  v_cvt_pk_bf16_f32 v243, v243, v243
  v_and_b32 v243, 0xffff0000, v243
  v_mul_f32 v112, 0xbfb8aa3b, v242
  v_exp_f32 v112, v112
  s_nop 0
  v_add_f32 v112, 1.0, v112
  s_load_dword s97, s[98:99], s3 glc
  v_mfma_f32_32x32x16_bf16 v[80:95], v[144:147], v[44:47], v[80:95]
  v_rcp_f32 v112, v112
  s_nop 0
  v_mul_f32 v242, v242, v112
  v_cvt_pk_bf16_f32 v242, v242, v242
  v_and_b32 v242, 0xffff0000, v242
  v_mul_f32 v242, v242, v243
  v_cvt_pk_bf16_f32 v242, v242, v242
  v_and_b32 v242, 0xffff0000, v242
  v_mul_f32 v232, v232, v242
  v_mul_f32 v233, v233, v242
  v_mul_f32 v234, v234, v242
  v_mul_f32 v235, v235, v242
  v_mfma_f32_32x32x16_bf16 v[96:111], v[148:151], v[40:43], v[96:111]
  v_mul_f32 v236, v236, v242
  v_mul_f32 v237, v237, v242
  v_mul_f32 v238, v238, v242
  v_mul_f32 v239, v239, v242
  v_permlane32_swap_b32 v232, v236
  v_permlane32_swap_b32 v233, v237
  v_permlane32_swap_b32 v234, v238
  v_permlane32_swap_b32 v235, v239
  v_add_f32 v232, v232, v236
  v_add_f32 v233, v233, v237
  v_add_f32 v234, v234, v238
  v_mfma_f32_32x32x16_bf16 v[200:215], v[148:151], v[44:47], v[200:215]
  v_add_f32 v235, v235, v239
  v_and_b32 v240, 7, v255
  v_lshlrev_b32 v240, 5, v240
  v_permlane16_swap_b32 v232, v234
  v_permlane16_swap_b32 v233, v235
  v_add_f32 v232, v232, v234
  v_add_f32 v233, v233, v235
  v_lshrrev_b32 v241, 4, v255
  v_lshl_add_u32 v240, v241, 3, v240
  v_add_f32_dpp v232, v232, v232 row_ror:8 row_mask:0xf bank_mask:0xf
  v_add_f32_dpp v233, v233, v233 row_ror:8 row_mask:0xf bank_mask:0xf
  s_xor_b32 s64, s77, 5120
  buffer_load_dwordx4 v[40:43], v251, s[24:27], s64 offen sc1
  s_xor_b32 s64, s78, 5120
  buffer_load_dwordx4 v[44:47], v251, s[24:27], s64 offen sc1
  s_waitcnt vmcnt(14)
  v_mfma_f32_32x32x16_bf16 v[64:79], v[152:155], v[48:51], v[64:79]
  s_lshl_b32 s65, s73, 11
  s_lshl_b32 s64, s52, 8
  s_add_u32 s65, s65, s64
  s_add_u32 s65, s65, 16908288
  s_cmp_lt_u32 s73, 172
  s_cselect_b32 s65, s65, 0x7f000000
  buffer_store_dwordx2 v[232:233], v240, s[24:27], s65 offen sc1
  v_mfma_f32_32x32x16_bf16 v[80:95], v[152:155], v[52:55], v[80:95]
  v_mfma_f32_32x32x16_bf16 v[96:111], v[156:159], v[48:51], v[96:111]
  v_mfma_f32_32x32x16_bf16 v[200:215], v[156:159], v[52:55], v[200:215]
  s_xor_b32 s64, s77, 6144
  buffer_load_dwordx4 v[48:51], v251, s[24:27], s64 offen sc1
  s_xor_b32 s64, s78, 6144
  buffer_load_dwordx4 v[52:55], v251, s[24:27], s64 offen sc1
  s_add_u32 s64, s57, 2048
  buffer_load_dwordx4 v[144:147], v251, s[24:27], s64 offen offset:0 sc1
  s_add_u32 s64, s57, 2048
  buffer_load_dwordx4 v[148:151], v251, s[24:27], s64 offen offset:1024 sc1
  s_waitcnt vmcnt(17)
  v_mfma_f32_32x32x16_bf16 v[64:79], v[136:139], v[56:59], v[64:79]
  v_mfma_f32_32x32x16_bf16 v[80:95], v[136:139], v[60:63], v[80:95]
  v_mfma_f32_32x32x16_bf16 v[96:111], v[140:143], v[56:59], v[96:111]
  v_mfma_f32_32x32x16_bf16 v[200:215], v[140:143], v[60:63], v[200:215]
  s_waitcnt lgkmcnt(0)
  s_mov_b32 s80, 0
Lspin_16:
  s_bfe_u32 s65, s97, 0x80008
  s_cmp_eq_u32 s65, 8
  s_cbranch_scc1 Lok_17
  s_sleep 4
  s_load_dword s97, s[98:99], s3 glc
  s_waitcnt lgkmcnt(0)
  s_add_u32 s80, s80, 1
  s_cmp_lt_u32 s80, 0x80000
  s_cbranch_scc1 Lspin_16
Lok_17:
  s_xor_b32 s64, s77, 7168
  buffer_load_dwordx4 v[56:59], v251, s[24:27], s64 offen sc1
  s_xor_b32 s64, s78, 7168
  buffer_load_dwordx4 v[60:63], v251, s[24:27], s64 offen sc1
  s_waitcnt vmcnt(9)
  v_mfma_f32_32x32x16_bf16 v[64:79], v[120:123], v[32:35], v[64:79]
  s_mov_b32 s96, 16777216
  s_atomic_add s96, s[98:99], s74
  v_mfma_f32_32x32x16_bf16 v[80:95], v[120:123], v[36:39], v[80:95]
  v_mfma_f32_32x32x16_bf16 v[96:111], v[124:127], v[32:35], v[96:111]
  v_mfma_f32_32x32x16_bf16 v[200:215], v[124:127], v[36:39], v[200:215]
  s_xor_b32 s64, s77, 4194304
  buffer_load_dwordx4 v[32:35], v251, s[24:27], s64 offen sc1
  s_xor_b32 s64, s78, 4194304
  buffer_load_dwordx4 v[36:39], v251, s[24:27], s64 offen sc1
  s_waitcnt vmcnt(9)
  v_mfma_f32_32x32x16_bf16 v[64:79], v[128:131], v[40:43], v[64:79]
  v_mfma_f32_32x32x16_bf16 v[80:95], v[128:131], v[44:47], v[80:95]
  s_cmp_ge_u32 s73, 172
  s_cbranch_scc1 Ly_18
  s_lshl_b32 s68, s52, 7
  s_add_u32 s68, s68, 49152
  s_waitcnt vmcnt(8)
  s_mov_b32 s67, 1
  s_atomic_add s67, s[98:99], s68
Ly_18:
  s_setprio 0
  v_mfma_f32_32x32x16_bf16 v[96:111], v[132:135], v[40:43], v[96:111]
  v_mfma_f32_32x32x16_bf16 v[200:215], v[132:135], v[44:47], v[200:215]
  s_xor_b32 s64, s77, 4195328
  buffer_load_dwordx4 v[40:43], v251, s[24:27], s64 offen sc1
  s_xor_b32 s64, s78, 4195328
  buffer_load_dwordx4 v[44:47], v251, s[24:27], s64 offen sc1
  s_add_u32 s64, s57, 4096
  buffer_load_dwordx4 v[152:155], v251, s[24:27], s64 offen offset:0 sc1
  s_add_u32 s64, s57, 4096
  buffer_load_dwordx4 v[156:159], v251, s[24:27], s64 offen offset:1024 sc1
  s_waitcnt vmcnt(10)
  v_mfma_f32_32x32x16_bf16 v[64:79], v[160:163], v[48:51], v[64:79]
  v_mfma_f32_32x32x16_bf16 v[80:95], v[160:163], v[52:55], v[80:95]
  v_mfma_f32_32x32x16_bf16 v[96:111], v[164:167], v[48:51], v[96:111]
  v_mfma_f32_32x32x16_bf16 v[200:215], v[164:167], v[52:55], v[200:215]
  s_xor_b32 s64, s77, 4196352
  buffer_load_dwordx4 v[48:51], v251, s[24:27], s64 offen sc1
  s_xor_b32 s64, s78, 4196352
  buffer_load_dwordx4 v[52:55], v251, s[24:27], s64 offen sc1
  s_waitcnt vmcnt(8)
  v_mfma_f32_32x32x16_bf16 v[64:79], v[168:171], v[56:59], v[64:79]
  v_mfma_f32_32x32x16_bf16 v[80:95], v[168:171], v[60:63], v[80:95]
  v_mfma_f32_32x32x16_bf16 v[96:111], v[172:175], v[56:59], v[96:111]
  v_mfma_f32_32x32x16_bf16 v[200:215], v[172:175], v[60:63], v[200:215]
  s_xor_b32 s64, s77, 4197376
  buffer_load_dwordx4 v[56:59], v251, s[24:27], s64 offen sc1
  s_xor_b32 s64, s78, 4197376
  buffer_load_dwordx4 v[60:63], v251, s[24:27], s64 offen sc1
  s_waitcnt vmcnt(8)
  v_mfma_f32_32x32x16_bf16 v[64:79], v[144:147], v[32:35], v[64:79]
  v_mfma_f32_32x32x16_bf16 v[80:95], v[144:147], v[36:39], v[80:95]
  v_mfma_f32_32x32x16_bf16 v[96:111], v[148:151], v[32:35], v[96:111]
  v_mfma_f32_32x32x16_bf16 v[200:215], v[148:151], v[36:39], v[200:215]
  s_xor_b32 s64, s77, 4198400
  buffer_load_dwordx4 v[32:35], v251, s[24:27], s64 offen sc1
  s_xor_b32 s64, s78, 4198400
  buffer_load_dwordx4 v[36:39], v251, s[24:27], s64 offen sc1
  s_add_u32 s64, s57, 6144
  buffer_load_dwordx4 v[136:139], v251, s[24:27], s64 offen offset:0 sc1
  s_add_u32 s64, s57, 6144
  buffer_load_dwordx4 v[140:143], v251, s[24:27], s64 offen offset:1024 sc1
  s_waitcnt vmcnt(10)
  v_mfma_f32_32x32x16_bf16 v[64:79], v[0:3], v[40:43], v[64:79]
  s_lshl_b32 s65, s52, 6
  v_add_u32 v198, s65, v255
  v_and_b32 v192, 7, v198
  v_lshrrev_b32 v198, 3, v198
  v_lshlrev_b32 v199, 3, v198
  v_lshlrev_b32 v192, 4, v192
  v_lshl_add_u32 v198, v198, 10, v192
  buffer_load_dwordx4 v[192:195], v198, s[4:7], s101 offen
  s_lshl_b32 s65, s100, 9
  s_add_u32 s65, s65, 16777216
  buffer_load_dwordx2 v[196:197], v199, s[24:27], s65 offen sc1
  s_load_dword s97, s[98:99], s3 glc
  v_mfma_f32_32x32x16_bf16 v[80:95], v[0:3], v[44:47], v[80:95]
  v_mfma_f32_32x32x16_bf16 v[96:111], v[4:7], v[40:43], v[96:111]
  v_mfma_f32_32x32x16_bf16 v[200:215], v[4:7], v[44:47], v[200:215]
  s_xor_b32 s64, s77, 4199424
  buffer_load_dwordx4 v[40:43], v251, s[24:27], s64 offen sc1
  s_xor_b32 s64, s78, 4199424
  buffer_load_dwordx4 v[44:47], v251, s[24:27], s64 offen sc1
  s_waitcnt vmcnt(10)
  v_mfma_f32_32x32x16_bf16 v[64:79], v[8:11], v[48:51], v[64:79]
  v_mfma_f32_32x32x16_bf16 v[80:95], v[8:11], v[52:55], v[80:95]
  v_mfma_f32_32x32x16_bf16 v[96:111], v[12:15], v[48:51], v[96:111]
  v_mfma_f32_32x32x16_bf16 v[200:215], v[12:15], v[52:55], v[200:215]
  s_xor_b32 s64, s77, 4200448
  buffer_load_dwordx4 v[48:51], v251, s[24:27], s64 offen sc1
  s_xor_b32 s64, s78, 4200448
  buffer_load_dwordx4 v[52:55], v251, s[24:27], s64 offen sc1
  s_waitcnt vmcnt(10)
  v_mfma_f32_32x32x16_bf16 v[64:79], v[152:155], v[56:59], v[64:79]
  v_mfma_f32_32x32x16_bf16 v[80:95], v[152:155], v[60:63], v[80:95]
  v_mfma_f32_32x32x16_bf16 v[96:111], v[156:159], v[56:59], v[96:111]
  v_mfma_f32_32x32x16_bf16 v[200:215], v[156:159], v[60:63], v[200:215]
  s_waitcnt lgkmcnt(0)
  s_mov_b32 s80, 0
Lspin_19:
  s_bfe_u32 s65, s97, 0x80010
  s_cmp_eq_u32 s65, 8
  s_cbranch_scc1 Lok_20
  s_sleep 4
  s_load_dword s97, s[98:99], s3 glc
  s_waitcnt lgkmcnt(0)
  s_add_u32 s80, s80, 1
  s_cmp_lt_u32 s80, 0x80000
  s_cbranch_scc1 Lspin_19
Lok_20:
  s_xor_b32 s64, s77, 4201472
  buffer_load_dwordx4 v[56:59], v251, s[24:27], s64 offen sc1
  s_xor_b32 s64, s78, 4201472
  buffer_load_dwordx4 v[60:63], v251, s[24:27], s64 offen sc1
  s_add_u32 s64, s57, 8192
  buffer_load_dwordx4 v[128:131], v251, s[24:27], s64 offen offset:0 sc1
  s_add_u32 s64, s57, 8192
  buffer_load_dwordx4 v[132:135], v251, s[24:27], s64 offen offset:1024 sc1
  s_waitcnt vmcnt(12)
  v_mfma_f32_32x32x16_bf16 v[64:79], v[16:19], v[32:35], v[64:79]
  v_mfma_f32_32x32x16_bf16 v[80:95], v[16:19], v[36:39], v[80:95]
  v_mfma_f32_32x32x16_bf16 v[96:111], v[20:23], v[32:35], v[96:111]
  v_mfma_f32_32x32x16_bf16 v[200:215], v[20:23], v[36:39], v[200:215]
  s_xor_b32 s64, s77, 8388608
  buffer_load_dwordx4 v[32:35], v251, s[24:27], s64 offen sc1
  s_xor_b32 s64, s78, 8388608
  buffer_load_dwordx4 v[36:39], v251, s[24:27], s64 offen sc1
  s_waitcnt vmcnt(8)
  v_mfma_f32_32x32x16_bf16 v[64:79], v[24:27], v[40:43], v[64:79]
  s_cmp_eq_u32 s79, 0
  s_cbranch_scc1 Lo_21
  s_lshl_b32 s70, s63, 7
  s_add_u32 s70, s70, 49152
  s_load_dword s97, s[98:99], s70 glc
Lo_21:
  v_mfma_f32_32x32x16_bf16 v[80:95], v[24:27], v[44:47], v[80:95]
  v_mfma_f32_32x32x16_bf16 v[96:111], v[28:31], v[40:43], v[96:111]
  v_mfma_f32_32x32x16_bf16 v[200:215], v[28:31], v[44:47], v[200:215]
  s_xor_b32 s64, s77, 8389632
  buffer_load_dwordx4 v[40:43], v251, s[24:27], s64 offen sc1
  s_xor_b32 s64, s78, 8389632
  buffer_load_dwordx4 v[44:47], v251, s[24:27], s64 offen sc1
  s_waitcnt vmcnt(8)
  v_mfma_f32_32x32x16_bf16 v[64:79], v[136:139], v[48:51], v[64:79]
  v_mfma_f32_32x32x16_bf16 v[80:95], v[136:139], v[52:55], v[80:95]
  v_mfma_f32_32x32x16_bf16 v[96:111], v[140:143], v[48:51], v[96:111]
  v_mfma_f32_32x32x16_bf16 v[200:215], v[140:143], v[52:55], v[200:215]
  s_xor_b32 s64, s77, 8390656
  buffer_load_dwordx4 v[48:51], v251, s[24:27], s64 offen sc1
  s_xor_b32 s64, s78, 8390656
  buffer_load_dwordx4 v[52:55], v251, s[24:27], s64 offen sc1
  s_add_u32 s64, s57, 10240
  buffer_load_dwordx4 v[144:147], v251, s[24:27], s64 offen offset:0 sc1
  s_add_u32 s64, s57, 10240
  buffer_load_dwordx4 v[148:151], v251, s[24:27], s64 offen offset:1024 sc1
  s_waitcnt vmcnt(10)
  v_mfma_f32_32x32x16_bf16 v[64:79], v[216:219], v[56:59], v[64:79]
  s_cmp_eq_u32 s79, 0
  s_cbranch_scc1 Lo_22
  s_waitcnt lgkmcnt(0)
  s_mov_b32 s80, 0
Lspin_23:
  s_bfe_u32 s65, s97, 0x80000
  s_cmp_eq_u32 s65, 172
  s_cbranch_scc1 Lok_24
  s_sleep 4
  s_load_dword s97, s[98:99], s70 glc
  s_waitcnt lgkmcnt(0)
  s_add_u32 s80, s80, 1
  s_cmp_lt_u32 s80, 0x80000
  s_cbranch_scc1 Lspin_23
Lok_24:
  v_lshrrev_b32 v246, 4, v255
  s_lshl_b32 s65, s52, 2
  v_add_u32 v246, s65, v246
  v_cmp_gt_u32 vcc, 12, v246
  v_lshlrev_b32 v246, 11, v246
  v_and_b32 v245, 15, v255
  v_lshl_add_u32 v246, v245, 4, v246
  v_mov_b32 v245, 0x7f000000
  v_cndmask_b32 v245, v245, v246, vcc
  s_lshl_b32 s65, s63, 8
  s_add_u32 s65, s65, 16908288
  buffer_load_dwordx4 v[0:3], v246, s[24:27], s65 offen sc1
  s_add_u32 s65, s65, 65536
  buffer_load_dwordx4 v[4:7], v246, s[24:27], s65 offen sc1
  s_add_u32 s65, s65, 65536
  buffer_load_dwordx4 v[8:11], v246, s[24:27], s65 offen sc1
  s_add_u32 s65, s65, 65536
  buffer_load_dwordx4 v[12:15], v246, s[24:27], s65 offen sc1
  s_add_u32 s65, s65, 65536
  buffer_load_dwordx4 v[16:19], v246, s[24:27], s65 offen sc1
  s_add_u32 s65, s65, 65536
  buffer_load_dwordx4 v[20:23], v245, s[24:27], s65 offen sc1
Lo_22:
  v_mfma_f32_32x32x16_bf16 v[80:95], v[216:219], v[60:63], v[80:95]
  v_mfma_f32_32x32x16_bf16 v[96:111], v[220:223], v[56:59], v[96:111]
  v_mfma_f32_32x32x16_bf16 v[200:215], v[220:223], v[60:63], v[200:215]
  s_xor_b32 s64, s77, 8391680
  buffer_load_dwordx4 v[56:59], v251, s[24:27], s64 offen sc1
  s_xor_b32 s64, s78, 8391680
  buffer_load_dwordx4 v[60:63], v251, s[24:27], s64 offen sc1
  s_waitcnt vmcnt(8)
  v_mfma_f32_32x32x16_bf16 v[64:79], v[224:227], v[32:35], v[64:79]
  v_lshlrev_b32 v216, 16, v192
  v_and_b32 v217, 0xffff0000, v192
  v_lshlrev_b32 v218, 16, v193
  v_mfma_f32_32x32x16_bf16 v[80:95], v[224:227], v[36:39], v[80:95]
  v_and_b32 v219, 0xffff0000, v193
  v_lshlrev_b32 v220, 16, v194
  v_and_b32 v221, 0xffff0000, v194
  v_lshlrev_b32 v222, 16, v195
  v_mfma_f32_32x32x16_bf16 v[96:111], v[228:231], v[32:35], v[96:111]
  v_and_b32 v223, 0xffff0000, v195
  v_sub_f32 v216, v216, v196
  v_sub_f32 v217, v217, v196
  v_mfma_f32_32x32x16_bf16 v[200:215], v[228:231], v[36:39], v[200:215]
  v_sub_f32 v218, v218, v196
  v_sub_f32 v219, v219, v196
  v_sub_f32 v220, v220, v196
  v_sub_f32 v221, v221, v196
  s_xor_b32 s64, s77, 8392704
  buffer_load_dwordx4 v[32:35], v251, s[24:27], s64 offen sc1
  s_xor_b32 s64, s78, 8392704
  buffer_load_dwordx4 v[36:39], v251, s[24:27], s64 offen sc1
  v_add_u32 v240, 131072, v252
  ds_read_b128 v[176:179], v240 offset:0
  ds_read_b128 v[180:183], v240 offset:1024
  ds_read_b32 v241, v240
  ds_read_b32 v241, v240
  s_waitcnt vmcnt(8)
  v_mfma_f32_32x32x16_bf16 v[64:79], v[128:131], v[40:43], v[64:79]
  v_sub_f32 v222, v222, v196
  v_sub_f32 v223, v223, v196
  v_cvt_pk_bf16_f32 v112, v216, v217
  v_lshlrev_b32 v216, 16, v112
  s_load_dword s97, s[98:99], s3 glc
  v_mfma_f32_32x32x16_bf16 v[80:95], v[128:131], v[44:47], v[80:95]
  v_and_b32 v217, 0xffff0000, v112
  v_cvt_pk_bf16_f32 v112, v218, v219
  v_lshlrev_b32 v218, 16, v112
  v_mfma_f32_32x32x16_bf16 v[96:111], v[132:135], v[40:43], v[96:111]
  v_and_b32 v219, 0xffff0000, v112
  v_cvt_pk_bf16_f32 v112, v220, v221
  v_lshlrev_b32 v220, 16, v112
  v_and_b32 v221, 0xffff0000, v112
  v_mfma_f32_32x32x16_bf16 v[200:215], v[132:135], v[44:47], v[200:215]
  v_cvt_pk_bf16_f32 v112, v222, v223
  v_lshlrev_b32 v222, 16, v112
  v_and_b32 v223, 0xffff0000, v112
  s_xor_b32 s64, s77, 8393728
  buffer_load_dwordx4 v[40:43], v251, s[24:27], s64 offen sc1
  s_xor_b32 s64, s78, 8393728
  buffer_load_dwordx4 v[44:47], v251, s[24:27], s64 offen sc1
  s_add_u32 s64, s57, 12288
  buffer_load_dwordx4 v[152:155], v251, s[24:27], s64 offen offset:0 sc1
  s_add_u32 s64, s57, 12288
  buffer_load_dwordx4 v[156:159], v251, s[24:27], s64 offen offset:1024 sc1
  v_add_u32 v240, 0, v252
  ds_read_b128 v[184:187], v240 offset:0
  ds_read_b128 v[188:191], v240 offset:1024
  ds_read_b32 v241, v240
  ds_read_b32 v241, v240
  s_waitcnt lgkmcnt(6)
  s_waitcnt vmcnt(10)
  v_mfma_f32_32x32x16_bf16 v[64:79], v[176:179], v[48:51], v[64:79]
  v_mul_f32 v216, v216, v197
  v_mul_f32 v217, v217, v197
  v_mul_f32 v218, v218, v197
  v_mul_f32 v219, v219, v197
  v_mfma_f32_32x32x16_bf16 v[80:95], v[176:179], v[52:55], v[80:95]
  v_mul_f32 v220, v220, v197
  v_mul_f32 v221, v221, v197
  v_mul_f32 v222, v222, v197
  v_mul_f32 v223, v223, v197
  v_mfma_f32_32x32x16_bf16 v[96:111], v[180:183], v[48:51], v[96:111]
  v_cvt_pk_bf16_f32 v112, v216, v217
  v_lshlrev_b32 v216, 16, v112
  v_and_b32 v217, 0xffff0000, v112
  v_mfma_f32_32x32x16_bf16 v[200:215], v[180:183], v[52:55], v[200:215]
  v_cvt_pk_bf16_f32 v112, v218, v219
  v_lshlrev_b32 v218, 16, v112
  v_and_b32 v219, 0xffff0000, v112
  v_cvt_pk_bf16_f32 v112, v220, v221
  s_xor_b32 s64, s77, 8394752
  buffer_load_dwordx4 v[48:51], v251, s[24:27], s64 offen sc1
  s_xor_b32 s64, s78, 8394752
  buffer_load_dwordx4 v[52:55], v251, s[24:27], s64 offen sc1
  s_waitcnt lgkmcnt(2)
  s_waitcnt vmcnt(8)
  v_mfma_f32_32x32x16_bf16 v[64:79], v[184:187], v[56:59], v[64:79]
  v_lshlrev_b32 v220, 16, v112
  v_and_b32 v221, 0xffff0000, v112
  v_cvt_pk_bf16_f32 v112, v222, v223
  v_mfma_f32_32x32x16_bf16 v[80:95], v[184:187], v[60:63], v[80:95]
  v_lshlrev_b32 v222, 16, v112
  v_and_b32 v223, 0xffff0000, v112
  v_mul_f32 v112, 0xbfb8aa3b, v216
  v_mul_f32 v113, 0xbfb8aa3b, v217
  v_mfma_f32_32x32x16_bf16 v[96:111], v[188:191], v[56:59], v[96:111]
  v_mul_f32 v114, 0xbfb8aa3b, v218
  v_mul_f32 v115, 0xbfb8aa3b, v219
  v_mul_f32 v116, 0xbfb8aa3b, v220
  v_mul_f32 v117, 0xbfb8aa3b, v221
  v_mfma_f32_32x32x16_bf16 v[200:215], v[188:191], v[60:63], v[200:215]
  v_mul_f32 v118, 0xbfb8aa3b, v222
  v_mul_f32 v119, 0xbfb8aa3b, v223
  v_exp_f32 v112, v112
  s_waitcnt lgkmcnt(0)
  s_mov_b32 s80, 0
Lspin_25:
  s_bfe_u32 s65, s97, 0x80018
  s_cmp_eq_u32 s65, 8
  s_cbranch_scc1 Lok_26
  s_sleep 4
  s_load_dword s97, s[98:99], s3 glc
  s_waitcnt lgkmcnt(0)
  s_add_u32 s80, s80, 1
  s_cmp_lt_u32 s80, 0x80000
  s_cbranch_scc1 Lspin_25
Lok_26:
  s_xor_b32 s64, s77, 8395776
  buffer_load_dwordx4 v[56:59], v251, s[24:27], s64 offen sc1
  s_xor_b32 s64, s78, 8395776
  buffer_load_dwordx4 v[60:63], v251, s[24:27], s64 offen sc1
  v_add_u32 v240, 2048, v252
  ds_read_b128 v[176:179], v240 offset:0
  ds_read_b128 v[180:183], v240 offset:1024
  ds_read_b32 v241, v240
  ds_read_b32 v241, v240
  s_waitcnt vmcnt(8)
  v_mfma_f32_32x32x16_bf16 v[64:79], v[144:147], v[32:35], v[64:79]
  v_exp_f32 v113, v113
  v_exp_f32 v114, v114
  v_exp_f32 v115, v115
  v_exp_f32 v116, v116
  v_mfma_f32_32x32x16_bf16 v[80:95], v[144:147], v[36:39], v[80:95]
  v_exp_f32 v117, v117
  v_exp_f32 v118, v118
  v_exp_f32 v119, v119
  v_mfma_f32_32x32x16_bf16 v[96:111], v[148:151], v[32:35], v[96:111]
  v_add_f32 v112, 1.0, v112
  v_add_f32 v113, 1.0, v113
  v_add_f32 v114, 1.0, v114
  v_add_f32 v115, 1.0, v115
  v_mfma_f32_32x32x16_bf16 v[200:215], v[148:151], v[36:39], v[200:215]
  v_add_f32 v116, 1.0, v116
  v_add_f32 v117, 1.0, v117
  v_add_f32 v118, 1.0, v118
  v_add_f32 v119, 1.0, v119
  s_xor_b32 s64, s77, 12582912
  buffer_load_dwordx4 v[32:35], v251, s[24:27], s64 offen sc1
  s_xor_b32 s64, s78, 12582912
  buffer_load_dwordx4 v[36:39], v251, s[24:27], s64 offen sc1
  s_add_u32 s64, s57, 14336
  buffer_load_dwordx4 v[136:139], v251, s[24:27], s64 offen offset:0 sc1
  s_add_u32 s64, s57, 14336
  buffer_load_dwordx4 v[140:143], v251, s[24:27], s64 offen offset:1024 sc1
  v_add_u32 v240, 32768, v252
  ds_read_b128 v[184:187], v240 offset:0
  ds_read_b128 v[188:191], v240 offset:1024
  ds_read_b32 v241, v240
  ds_read_b32 v241, v240
  s_waitcnt lgkmcnt(6)
  s_waitcnt vmcnt(10)
  v_mfma_f32_32x32x16_bf16 v[64:79], v[176:179], v[40:43], v[64:79]
  v_rcp_f32 v112, v112
  v_rcp_f32 v113, v113
  v_rcp_f32 v114, v114
  s_cmp_eq_u32 s79, 0
  s_cbranch_scc1 Lo_27
  v_add_f32 v0, v0, v4
  v_add_f32 v1, v1, v5
  v_add_f32 v2, v2, v6
  v_add_f32 v3, v3, v7
  v_add_f32 v0, v0, v8
  v_add_f32 v1, v1, v9
  v_add_f32 v2, v2, v10
  v_add_f32 v3, v3, v11
  v_add_f32 v0, v0, v12
  v_add_f32 v1, v1, v13
  v_add_f32 v2, v2, v14
  v_add_f32 v3, v3, v15
  v_add_f32 v0, v0, v16
  v_add_f32 v1, v1, v17
  v_add_f32 v2, v2, v18
  v_add_f32 v3, v3, v19
  v_add_f32 v0, v0, v20
  v_add_f32 v1, v1, v21
  v_add_f32 v2, v2, v22
  v_add_f32 v3, v3, v23
  s_nop 0
  v_permlane32_swap_b32 v0, v2
  v_permlane32_swap_b32 v1, v3
  v_add_f32 v0, v0, v2
  v_add_f32 v1, v1, v3
  s_nop 1
  v_permlane16_swap_b32 v0, v1
  v_add_f32 v0, v0, v1
  v_and_b32 v246, 15, v255
  v_lshrrev_b32 v245, 4, v255
  v_lshl_add_u32 v246, v246, 2, v245
  v_lshlrev_b32 v246, 2, v246
  s_add_u32 s65, s55, 134144
  v_add_u32 v246, s65, v246
  ds_write_b32 v246, v0
Lo_27:
  v_mfma_f32_32x32x16_bf16 v[80:95], v[176:179], v[44:47], v[80:95]
  v_rcp_f32 v115, v115
  v_rcp_f32 v116, v116
  v_rcp_f32 v117, v117
  v_rcp_f32 v118, v118
  v_mfma_f32_32x32x16_bf16 v[96:111], v[180:183], v[40:43], v[96:111]
  v_rcp_f32 v119, v119
  v_mul_f32 v224, v216, v112
  v_mul_f32 v225, v217, v113
  v_mfma_f32_32x32x16_bf16 v[200:215], v[180:183], v[44:47], v[200:215]
  v_mul_f32 v226, v218, v114
  v_mul_f32 v227, v219, v115
  v_mul_f32 v228, v220, v116
  v_mul_f32 v229, v221, v117
  s_xor_b32 s64, s77, 12583936
  buffer_load_dwordx4 v[40:43], v251, s[24:27], s64 offen sc1
  s_xor_b32 s64, s78, 12583936
  buffer_load_dwordx4 v[44:47], v251, s[24:27], s64 offen sc1
  s_waitcnt lgkmcnt(2)
  s_waitcnt vmcnt(8)
  v_mfma_f32_32x32x16_bf16 v[64:79], v[184:187], v[48:51], v[64:79]
  v_mul_f32 v230, v222, v118
  v_mul_f32 v231, v223, v119
  v_cvt_pk_bf16_f32 v112, v224, v225
  v_lshlrev_b32 v224, 16, v112
  v_mfma_f32_32x32x16_bf16 v[80:95], v[184:187], v[52:55], v[80:95]
  v_and_b32 v225, 0xffff0000, v112
  v_cvt_pk_bf16_f32 v112, v226, v227
  v_lshlrev_b32 v226, 16, v112
  v_mfma_f32_32x32x16_bf16 v[96:111], v[188:191], v[48:51], v[96:111]
  v_and_b32 v227, 0xffff0000, v112
  v_cvt_pk_bf16_f32 v112, v228, v229
  v_lshlrev_b32 v228, 16, v112
  v_and_b32 v229, 0xffff0000, v112
  v_mfma_f32_32x32x16_bf16 v[200:215], v[188:191], v[52:55], v[200:215]
  v_cvt_pk_bf16_f32 v112, v230, v231
  v_lshlrev_b32 v230, 16, v112
  v_and_b32 v231, 0xffff0000, v112
  s_xor_b32 s64, s77, 12584960
  buffer_load_dwordx4 v[48:51], v251, s[24:27], s64 offen sc1
  s_xor_b32 s64, s78, 12584960
  buffer_load_dwordx4 v[52:55], v251, s[24:27], s64 offen sc1
  v_add_u32 v240, 34816, v252
  ds_read_b128 v[176:179], v240 offset:0
  ds_read_b128 v[180:183], v240 offset:1024
  ds_read_b32 v241, v240
  ds_read_b32 v241, v240
  s_waitcnt vmcnt(8)
  v_mfma_f32_32x32x16_bf16 v[64:79], v[152:155], v[56:59], v[64:79]
  v_mfma_f32_32x32x16_bf16 v[80:95], v[152:155], v[60:63], v[80:95]
  v_mfma_f32_32x32x16_bf16 v[96:111], v[156:159], v[56:59], v[96:111]
  v_mfma_f32_32x32x16_bf16 v[200:215], v[156:159], v[60:63], v[200:215]
  s_xor_b32 s64, s77, 12585984
  buffer_load_dwordx4 v[56:59], v251, s[24:27], s64 offen sc1
  s_xor_b32 s64, s78, 12585984
  buffer_load_dwordx4 v[60:63], v251, s[24:27], s64 offen sc1
  s_add_u32 s64, s57, 16384
  buffer_load_dwordx4 v[128:131], v251, s[24:27], s64 offen offset:0 sc1
  s_add_u32 s64, s57, 16384
  buffer_load_dwordx4 v[132:135], v251, s[24:27], s64 offen offset:1024 sc1
  v_add_u32 v240, 65536, v252
  ds_read_b128 v[184:187], v240 offset:0
  ds_read_b128 v[188:191], v240 offset:1024
  ds_read_b32 v241, v240
  ds_read_b32 v241, v240
  s_waitcnt lgkmcnt(6)
  s_waitcnt vmcnt(10)
  v_mfma_f32_32x32x16_bf16 v[64:79], v[176:179], v[32:35], v[64:79]
  s_cmp_eq_u32 s79, 0
  s_cbranch_scc1 Lo_28
  s_waitcnt lgkmcnt(0)
  s_barrier
  s_bfe_u32 s64, s75, 0x30003
  s_cmp_lg_u32 s64, s52
  s_cbranch_scc1 Lo_28
  v_and_b32 v246, 7, v255
  v_lshlrev_b32 v246, 5, v246
  v_add_u32 v246, 134144, v246
  ds_read_b128 v[0:3], v246 offset:0
  ds_read_b128 v[4:7], v246 offset:16
  ds_read_b128 v[8:11], v246 offset:4096
  ds_read_b128 v[12:15], v246 offset:4112
  ds_read_b128 v[16:19], v246 offset:8192
  ds_read_b128 v[20:23], v246 offset:8208
  ds_read_b128 v[24:27], v246 offset:12288
  ds_read_b128 v[28:31], v246 offset:12304
  s_lshr_b32 s64, s76, 16
  s_mov_b32 s65, 0xffff
  s_bitcmp1_b32 s64, 15
  s_cselect_b32 s65, 0x8000, s65
  s_xor_b32 s64, s64, s65
  s_lshl_b32 s64, s64, 16
  v_mov_b32 v245, s64
  v_mul_f32 v245, 0xbfb8aa3b, v245
  v_exp_f32 v245, v245
  s_waitcnt lgkmcnt(0)
  v_add_f32 v0, v0, v8
  v_add_f32 v1, v1, v9
  v_add_f32 v2, v2, v10
  v_add_f32 v3, v3, v11
  v_add_f32 v4, v4, v12
  v_add_f32 v5, v5, v13
  v_add_f32 v6, v6, v14
  v_add_f32 v7, v7, v15
  v_add_f32 v0, v0, v16
  v_add_f32 v1, v1, v17
  v_add_f32 v2, v2, v18
  v_add_f32 v3, v3, v19
  v_add_f32 v4, v4, v20
  v_add_f32 v5, v5, v21
  v_add_f32 v6, v6, v22
  v_add_f32 v7, v7, v23
  v_add_f32 v0, v0, v24
  v_add_f32 v1, v1, v25
  v_add_f32 v2, v2, v26
  v_add_f32 v3, v3, v27
  v_add_f32 v4, v4, v28
  v_add_f32 v5, v5, v29
  v_add_f32 v6, v6, v30
  v_add_f32 v7, v7, v31
  ds_read_b128 v[8:11], v246 offset:16384
  ds_read_b128 v[12:15], v246 offset:16400
  ds_read_b128 v[16:19], v246 offset:20480
  ds_read_b128 v[20:23], v246 offset:20496
  ds_read_b128 v[24:27], v246 offset:24576
  ds_read_b128 v[28:31], v246 offset:24592
  ds_read_b128 v[112:115], v246 offset:28672
  ds_read_b128 v[116:119], v246 offset:28688
  v_add_f32 v245, 1.0, v245
  v_rcp_f32 v245, v245
  s_nop 0
  v_cvt_pk_bf16_f32 v245, v245, v245
  v_and_b32 v245, 0xffff0000, v245
  v_lshrrev_b32 v246, 3, v255
  s_and_b32 s64, s75, 7
  v_cmp_eq_u32 vcc, s64, v246
  s_waitcnt lgkmcnt(0)
  v_add_f32 v0, v0, v8
  v_add_f32 v1, v1, v9
  v_add_f32 v2, v2, v10
  v_add_f32 v3, v3, v11
  v_add_f32 v4, v4, v12
  v_add_f32 v5, v5, v13
  v_add_f32 v6, v6, v14
  v_add_f32 v7, v7, v15
  v_add_f32 v0, v0, v16
  v_add_f32 v1, v1, v17
  v_add_f32 v2, v2, v18
  v_add_f32 v3, v3, v19
  v_add_f32 v4, v4, v20
  v_add_f32 v5, v5, v21
  v_add_f32 v6, v6, v22
  v_add_f32 v7, v7, v23
  v_add_f32 v0, v0, v24
  v_add_f32 v1, v1, v25
  v_add_f32 v2, v2, v26
  v_add_f32 v3, v3, v27
  v_add_f32 v4, v4, v28
  v_add_f32 v5, v5, v29
  v_add_f32 v6, v6, v30
  v_add_f32 v7, v7, v31
  v_add_f32 v0, v0, v112
  v_add_f32 v1, v1, v113
  v_add_f32 v2, v2, v114
  v_add_f32 v3, v3, v115
  v_add_f32 v4, v4, v116
  v_add_f32 v5, v5, v117
  v_add_f32 v6, v6, v118
  v_add_f32 v7, v7, v119
  v_cvt_pk_bf16_f32 v112, v0, v1
  v_lshlrev_b32 v0, 16, v112
  v_and_b32 v1, 0xffff0000, v112
  v_cvt_pk_bf16_f32 v112, v2, v3
  v_lshlrev_b32 v2, 16, v112
  v_and_b32 v3, 0xffff0000, v112
  v_cvt_pk_bf16_f32 v112, v4, v5
  v_lshlrev_b32 v4, 16, v112
  v_and_b32 v5, 0xffff0000, v112
  v_cvt_pk_bf16_f32 v112, v6, v7
  v_lshlrev_b32 v6, 16, v112
  v_and_b32 v7, 0xffff0000, v112
  v_mul_f32 v0, v0, v245
  v_mul_f32 v1, v1, v245
  v_mul_f32 v2, v2, v245
  v_mul_f32 v3, v3, v245
  v_mul_f32 v4, v4, v245
  v_mul_f32 v5, v5, v245
  v_mul_f32 v6, v6, v245
  v_mul_f32 v7, v7, v245
  v_cvt_pk_bf16_f32 v112, v0, v1
  v_lshlrev_b32 v0, 16, v112
  v_and_b32 v1, 0xffff0000, v112
  v_cvt_pk_bf16_f32 v112, v2, v3
  v_lshlrev_b32 v2, 16, v112
  v_and_b32 v3, 0xffff0000, v112
  v_cvt_pk_bf16_f32 v112, v4, v5
  v_lshlrev_b32 v4, 16, v112
  v_and_b32 v5, 0xffff0000, v112
  v_cvt_pk_bf16_f32 v112, v6, v7
  v_lshlrev_b32 v6, 16, v112
  v_and_b32 v7, 0xffff0000, v112
  v_add_f32 v0, v0, v216
  v_add_f32 v1, v1, v217
  v_add_f32 v2, v2, v218
  v_add_f32 v3, v3, v219
  v_add_f32 v4, v4, v220
  v_add_f32 v5, v5, v221
  v_add_f32 v6, v6, v222
  v_add_f32 v7, v7, v223
  v_cvt_pk_bf16_f32 v112, v0, v1
  v_lshlrev_b32 v0, 16, v112
  v_and_b32 v1, 0xffff0000, v112
  v_cvt_pk_bf16_f32 v112, v2, v3
  v_lshlrev_b32 v2, 16, v112
  v_and_b32 v3, 0xffff0000, v112
  v_cvt_pk_bf16_f32 v112, v4, v5
  v_lshlrev_b32 v4, 16, v112
  v_and_b32 v5, 0xffff0000, v112
  v_cvt_pk_bf16_f32 v112, v6, v7
  v_lshlrev_b32 v6, 16, v112
  v_and_b32 v7, 0xffff0000, v112
  v_mul_f32 v112, 0xbfb8aa3b, v0
  v_mul_f32 v113, 0xbfb8aa3b, v1
  v_mul_f32 v114, 0xbfb8aa3b, v2
  v_mul_f32 v115, 0xbfb8aa3b, v3
  v_mul_f32 v116, 0xbfb8aa3b, v4
  v_mul_f32 v117, 0xbfb8aa3b, v5
  v_mul_f32 v118, 0xbfb8aa3b, v6
  v_mul_f32 v119, 0xbfb8aa3b, v7
  v_exp_f32 v112, v112
  v_exp_f32 v113, v113
  v_exp_f32 v114, v114
  v_exp_f32 v115, v115
  v_exp_f32 v116, v116
  v_exp_f32 v117, v117
  v_exp_f32 v118, v118
  v_exp_f32 v119, v119
  v_add_f32 v112, 1.0, v112
  v_add_f32 v113, 1.0, v113
  v_add_f32 v114, 1.0, v114
  v_add_f32 v115, 1.0, v115
  v_add_f32 v116, 1.0, v116
  v_add_f32 v117, 1.0, v117
  v_add_f32 v118, 1.0, v118
  v_add_f32 v119, 1.0, v119
  v_rcp_f32 v112, v112
  v_rcp_f32 v113, v113
  v_rcp_f32 v114, v114
  v_rcp_f32 v115, v115
  v_rcp_f32 v116, v116
  v_rcp_f32 v117, v117
  v_rcp_f32 v118, v118
  v_rcp_f32 v119, v119
  v_mul_f32 v8, v0, v112
  v_mul_f32 v9, v1, v113
  v_mul_f32 v10, v2, v114
  v_mul_f32 v11, v3, v115
  v_mul_f32 v12, v4, v116
  v_mul_f32 v13, v5, v117
  v_mul_f32 v14, v6, v118
  v_mul_f32 v15, v7, v119
  v_cvt_pk_bf16_f32 v112, v8, v9
  v_lshlrev_b32 v8, 16, v112
  v_and_b32 v9, 0xffff0000, v112
  v_cvt_pk_bf16_f32 v112, v10, v11
  v_lshlrev_b32 v10, 16, v112
  v_and_b32 v11, 0xffff0000, v112
  v_cvt_pk_bf16_f32 v112, v12, v13
  v_lshlrev_b32 v12, 16, v112
  v_and_b32 v13, 0xffff0000, v112
  v_cvt_pk_bf16_f32 v112, v14, v15
  v_lshlrev_b32 v14, 16, v112
  v_and_b32 v15, 0xffff0000, v112
  v_cndmask_b32 v224, v224, v8, vcc
  v_cndmask_b32 v225, v225, v9, vcc
  v_cndmask_b32 v226, v226, v10, vcc
  v_cndmask_b32 v227, v227, v11, vcc
  v_cndmask_b32 v228, v228, v12, vcc
  v_cndmask_b32 v229, v229, v13, vcc
  v_cndmask_b32 v230, v230, v14, vcc
  v_cndmask_b32 v231, v231, v15, vcc
Lo_28:
  v_mfma_f32_32x32x16_bf16 v[80:95], v[176:179], v[36:39], v[80:95]
  v_mfma_f32_32x32x16_bf16 v[96:111], v[180:183], v[32:35], v[96:111]
  v_mfma_f32_32x32x16_bf16 v[200:215], v[180:183], v[36:39], v[200:215]
  s_xor_b32 s64, s77, 12587008
  buffer_load_dwordx4 v[32:35], v251, s[24:27], s64 offen sc1
  s_xor_b32 s64, s78, 12587008
  buffer_load_dwordx4 v[36:39], v251, s[24:27], s64 offen sc1
  s_waitcnt lgkmcnt(2)
  s_waitcnt vmcnt(8)
  v_mfma_f32_32x32x16_bf16 v[64:79], v[184:187], v[40:43], v[64:79]
  v_mfma_f32_32x32x16_bf16 v[80:95], v[184:187], v[44:47], v[80:95]
  v_mfma_f32_32x32x16_bf16 v[96:111], v[188:191], v[40:43], v[96:111]
  v_mfma_f32_32x32x16_bf16 v[200:215], v[188:191], v[44:47], v[200:215]
  s_xor_b32 s64, s77, 12588032
  buffer_load_dwordx4 v[40:43], v251, s[24:27], s64 offen sc1
  s_xor_b32 s64, s78, 12588032
  buffer_load_dwordx4 v[44:47], v251, s[24:27], s64 offen sc1
  s_add_u32 s64, s57, 18432
  buffer_load_dwordx4 v[144:147], v251, s[24:27], s64 offen offset:0 sc1
  s_add_u32 s64, s57, 18432
  buffer_load_dwordx4 v[148:151], v251, s[24:27], s64 offen offset:1024 sc1
  v_add_u32 v240, 67584, v252
  ds_read_b128 v[176:179], v240 offset:0
  ds_read_b128 v[180:183], v240 offset:1024
  ds_read_b32 v241, v240
  ds_read_b32 v241, v240
  s_waitcnt vmcnt(10)
  v_mfma_f32_32x32x16_bf16 v[64:79], v[136:139], v[48:51], v[64:79]
  v_mfma_f32_32x32x16_bf16 v[80:95], v[136:139], v[52:55], v[80:95]
  v_and_b32 v168, 15, v255
  v_lshlrev_b32 v168, 8, v168
  v_and_b32 v169, 7, v255
  v_lshrrev_b32 v170, 5, v255
  v_xor_b32 v169, v169, v170
  v_lshl_add_u32 v168, v169, 4, v168
  v_add_u32 v168, s55, v168
  v_bfe_u32 v169, v255, 4, 1
  v_lshl_add_u32 v160, v169, 15, v168
  v_add_u32 v164, 65536, v160
  v_xor_b32 v161, 32, v160
  v_xor_b32 v165, 32, v164
  v_xor_b32 v162, 64, v160
  v_xor_b32 v166, 64, v164
  v_xor_b32 v163, 96, v160
  v_xor_b32 v167, 96, v164
  s_lshr_b32 s65, s52, 1
  s_lshl_b32 s65, s65, 15
  s_and_b32 s64, s52, 1
  s_lshl_b32 s64, s64, 11
  s_add_u32 s65, s65, s64
  v_lshrrev_b32 v170, 3, v255
  v_and_b32 v171, 7, v255
  v_lshlrev_b32 v171, 1, v171
  v_xor_b32 v171, v171, v170
  v_lshlrev_b32 v171, 4, v171
  v_lshl_add_u32 v170, v170, 8, v171
  v_add_u32 v170, s65, v170
  v_xor_b32 v171, 16, v170
  v_mfma_f32_32x32x16_bf16 v[96:111], v[140:143], v[48:51], v[96:111]
  v_mfma_f32_32x32x16_bf16 v[200:215], v[140:143], v[52:55], v[200:215]
  s_xor_b32 s64, s77, 12589056
  buffer_load_dwordx4 v[48:51], v251, s[24:27], s64 offen sc1
  s_xor_b32 s64, s78, 12589056
  buffer_load_dwordx4 v[52:55], v251, s[24:27], s64 offen sc1
  v_add_u32 v240, 98304, v252
  ds_read_b128 v[184:187], v240 offset:0
  ds_read_b128 v[188:191], v240 offset:1024
  ds_read_b32 v241, v240
  ds_read_b32 v241, v240
  s_waitcnt lgkmcnt(6)
  s_waitcnt vmcnt(10)
  v_mfma_f32_32x32x16_bf16 v[64:79], v[176:179], v[56:59], v[64:79]
  v_mfma_f32_32x32x16_bf16 v[80:95], v[176:179], v[60:63], v[80:95]
  v_mfma_f32_32x32x16_bf16 v[96:111], v[180:183], v[56:59], v[96:111]
  v_mfma_f32_32x32x16_bf16 v[200:215], v[180:183], v[60:63], v[200:215]
  s_xor_b32 s64, s77, 12590080
  buffer_load_dwordx4 v[56:59], v251, s[24:27], s64 offen sc1
  s_xor_b32 s64, s78, 12590080
  buffer_load_dwordx4 v[60:63], v251, s[24:27], s64 offen sc1
  s_waitcnt lgkmcnt(2)
  s_waitcnt vmcnt(8)
  v_mfma_f32_32x32x16_bf16 v[64:79], v[184:187], v[32:35], v[64:79]
  v_mfma_f32_32x32x16_bf16 v[80:95], v[184:187], v[36:39], v[80:95]
  v_mfma_f32_32x32x16_bf16 v[96:111], v[188:191], v[32:35], v[96:111]
  v_mfma_f32_32x32x16_bf16 v[200:215], v[188:191], v[36:39], v[200:215]
  v_add_u32 v240, 100352, v252
  ds_read_b128 v[176:179], v240 offset:0
  ds_read_b128 v[180:183], v240 offset:1024
  ds_read_b32 v241, v240
  ds_read_b32 v241, v240
  s_waitcnt vmcnt(6)
  v_mfma_f32_32x32x16_bf16 v[64:79], v[128:131], v[40:43], v[64:79]
  v_mfma_f32_32x32x16_bf16 v[80:95], v[128:131], v[44:47], v[80:95]
  v_mfma_f32_32x32x16_bf16 v[96:111], v[132:135], v[40:43], v[96:111]
  v_mfma_f32_32x32x16_bf16 v[200:215], v[132:135], v[44:47], v[200:215]
  s_waitcnt lgkmcnt(2)
  s_waitcnt vmcnt(0)
  v_mfma_f32_32x32x16_bf16 v[64:79], v[176:179], v[48:51], v[64:79]
  v_mfma_f32_32x32x16_bf16 v[64:79], v[144:147], v[56:59], v[64:79]
  v_mfma_f32_32x32x16_bf16 v[80:95], v[176:179], v[52:55], v[80:95]
  v_mfma_f32_32x32x16_bf16 v[80:95], v[144:147], v[60:63], v[80:95]
  v_mfma_f32_32x32x16_bf16 v[96:111], v[180:183], v[48:51], v[96:111]
  v_mfma_f32_32x32x16_bf16 v[96:111], v[148:151], v[56:59], v[96:111]
  s_nop 7
  ds_write_b128 v160, v[64:67] offset:0
  ds_write_b128 v161, v[68:71] offset:0
  ds_write_b128 v162, v[72:75] offset:0
  ds_write_b128 v163, v[76:79] offset:0
  v_mfma_f32_32x32x16_bf16 v[200:215], v[180:183], v[52:55], v[200:215]
  v_mfma_f32_32x32x16_bf16 v[200:215], v[148:151], v[60:63], v[200:215]
  s_nop 3
  ds_write_b128 v164, v[80:83] offset:0
  ds_write_b128 v165, v[84:87] offset:0
  ds_write_b128 v166, v[88:91] offset:0
  ds_write_b128 v167, v[92:95] offset:0
  s_nop 1
  ds_write_b128 v160, v[96:99] offset:128
  ds_write_b128 v161, v[100:103] offset:128
  ds_write_b128 v162, v[104:107] offset:128
  ds_write_b128 v163, v[108:111] offset:128
  s_nop 7
  ds_write_b128 v164, v[200:203] offset:128
  ds_write_b128 v165, v[204:207] offset:128
  ds_write_b128 v166, v[208:211] offset:128
  ds_write_b128 v167, v[212:215] offset:128
  s_waitcnt lgkmcnt(0)
  s_barrier
  ds_read_b128 v[0:3], v170 offset:0
  ds_read_b128 v[4:7], v171 offset:0
  ds_read_b128 v[8:11], v170 offset:4096
  ds_read_b128 v[12:15], v171 offset:4096
  ds_read_b128 v[16:19], v170 offset:8192
  ds_read_b128 v[20:23], v171 offset:8192
  ds_read_b128 v[24:27], v170 offset:12288
  ds_read_b128 v[28:31], v171 offset:12288
  ds_read_b128 v[32:35], v170 offset:16384
  ds_read_b128 v[36:39], v171 offset:16384
  ds_read_b128 v[40:43], v170 offset:20480
  ds_read_b128 v[44:47], v171 offset:20480
  ds_read_b128 v[48:51], v170 offset:24576
  ds_read_b128 v[52:55], v171 offset:24576
  ds_read_b128 v[56:59], v170 offset:28672
  ds_read_b128 v[60:63], v171 offset:28672
  v_lshlrev_b32 v216, 16, v192
  v_and_b32 v217, 0xffff0000, v192
  v_lshlrev_b32 v218, 16, v193
  v_and_b32 v219, 0xffff0000, v193
  v_lshlrev_b32 v220, 16, v194
  v_and_b32 v221, 0xffff0000, v194
  v_lshlrev_b32 v222, 16, v195
  v_and_b32 v223, 0xffff0000, v195
  s_waitcnt lgkmcnt(12)
  v_add_f32 v0, v0, v8
  v_add_f32 v1, v1, v9
  v_add_f32 v2, v2, v10
  v_add_f32 v3, v3, v11
  v_add_f32 v4, v4, v12
  v_add_f32 v5, v5, v13
  v_add_f32 v6, v6, v14
  v_add_f32 v7, v7, v15
  s_waitcnt lgkmcnt(10)
  v_add_f32 v0, v0, v16
  v_add_f32 v1, v1, v17
  v_add_f32 v2, v2, v18
  v_add_f32 v3, v3, v19
  v_add_f32 v4, v4, v20
  v_add_f32 v5, v5, v21
  v_add_f32 v6, v6, v22
  v_add_f32 v7, v7, v23
  s_waitcnt lgkmcnt(8)
  v_add_f32 v0, v0, v24
  v_add_f32 v1, v1, v25
  v_add_f32 v2, v2, v26
  v_add_f32 v3, v3, v27
  v_add_f32 v4, v4, v28
  v_add_f32 v5, v5, v29
  v_add_f32 v6, v6, v30
  v_add_f32 v7, v7, v31
  s_waitcnt lgkmcnt(6)
  v_add_f32 v0, v0, v32
  v_add_f32 v1, v1, v33
  v_add_f32 v2, v2, v34
  v_add_f32 v3, v3, v35
  v_add_f32 v4, v4, v36
  v_add_f32 v5, v5, v37
  v_add_f32 v6, v6, v38
  v_add_f32 v7, v7, v39
  s_waitcnt lgkmcnt(4)
  v_add_f32 v0, v0, v40
  v_add_f32 v1, v1, v41
  v_add_f32 v2, v2, v42
  v_add_f32 v3, v3, v43
  v_add_f32 v4, v4, v44
  v_add_f32 v5, v5, v45
  v_add_f32 v6, v6, v46
  v_add_f32 v7, v7, v47
  s_waitcnt lgkmcnt(2)
  v_add_f32 v0, v0, v48
  v_add_f32 v1, v1, v49
  v_add_f32 v2, v2, v50
  v_add_f32 v3, v3, v51
  v_add_f32 v4, v4, v52
  v_add_f32 v5, v5, v53
  v_add_f32 v6, v6, v54
  v_add_f32 v7, v7, v55
  s_waitcnt lgkmcnt(0)
  v_add_f32 v0, v0, v56
  v_add_f32 v1, v1, v57
  v_add_f32 v2, v2, v58
  v_add_f32 v3, v3, v59
  v_add_f32 v4, v4, v60
  v_add_f32 v5, v5, v61
  v_add_f32 v6, v6, v62
  v_add_f32 v7, v7, v63
  v_cvt_pk_bf16_f32 v112, v0, v1
  v_lshlrev_b32 v0, 16, v112
  v_and_b32 v1, 0xffff0000, v112
  v_cvt_pk_bf16_f32 v112, v2, v3
  v_lshlrev_b32 v2, 16, v112
  v_and_b32 v3, 0xffff0000, v112
  v_cvt_pk_bf16_f32 v112, v4, v5
  v_lshlrev_b32 v4, 16, v112
  v_and_b32 v5, 0xffff0000, v112
  v_cvt_pk_bf16_f32 v112, v6, v7
  v_lshlrev_b32 v6, 16, v112
  v_and_b32 v7, 0xffff0000, v112
  v_mul_f32 v0, v0, v224
  v_mul_f32 v1, v1, v225
  v_mul_f32 v2, v2, v226
  v_mul_f32 v3, v3, v227
  v_mul_f32 v4, v4, v228
  v_mul_f32 v5, v5, v229
  v_mul_f32 v6, v6, v230
  v_mul_f32 v7, v7, v231
  v_cvt_pk_bf16_f32 v112, v0, v1
  v_lshlrev_b32 v0, 16, v112
  v_and_b32 v1, 0xffff0000, v112
  v_cvt_pk_bf16_f32 v112, v2, v3
  v_lshlrev_b32 v2, 16, v112
  v_and_b32 v3, 0xffff0000, v112
  v_cvt_pk_bf16_f32 v112, v4, v5
  v_lshlrev_b32 v4, 16, v112
  v_and_b32 v5, 0xffff0000, v112
  v_cvt_pk_bf16_f32 v112, v6, v7
  v_lshlrev_b32 v6, 16, v112
  v_and_b32 v7, 0xffff0000, v112
  v_add_f32 v0, v0, v216
  v_add_f32 v1, v1, v217
  v_add_f32 v2, v2, v218
  v_add_f32 v3, v3, v219
  v_add_f32 v4, v4, v220
  v_add_f32 v5, v5, v221
  v_add_f32 v6, v6, v222
  v_add_f32 v7, v7, v223
  v_cvt_pk_bf16_f32 v8, v0, v1
  v_cvt_pk_bf16_f32 v9, v2, v3
  v_cvt_pk_bf16_f32 v10, v4, v5
  v_cvt_pk_bf16_f32 v11, v6, v7
  buffer_store_dwordx4 v[8:11], v198, s[32:35], s101 offen sc1
  s_endpgm
L_fallback:
  s_waitcnt lgkmcnt(0)
  s_nop 15
  v_and_b32 v136, 31, v255
  v_lshlrev_b32 v136, 8, v136
  v_lshrrev_b32 v137, 5, v255
  v_lshl_add_u32 v136, v137, 4, v136
  v_mov_b32 v137, 0xff800000
  s_andn2_b32 s66, s59, 0x3fff
  s_mov_b32 s65, 0
L_fb1:
  s_lshl_b32 s64, s65, 13
  s_xor_b32 s64, s64, s66
  buffer_load_dwordx4 v[176:179], v136, s[12:15], s64 offen offset:0
  buffer_load_dwordx4 v[180:183], v136, s[12:15], s64 offen offset:32
  buffer_load_dwordx4 v[184:187], v136, s[12:15], s64 offen offset:64
  buffer_load_dwordx4 v[188:191], v136, s[12:15], s64 offen offset:96
  s_waitcnt vmcnt(0)
  v_mfma_f32_32x32x16_bf16 v[216:231], v[176:179], v[144:147], 0
  v_mfma_f32_32x32x16_bf16 v[216:231], v[180:183], v[148:151], v[216:231]
  v_mfma_f32_32x32x16_bf16 v[216:231], v[184:187], v[152:155], v[216:231]
  v_mfma_f32_32x32x16_bf16 v[216:231], v[188:191], v[156:159], v[216:231]
  buffer_load_dwordx4 v[176:179], v136, s[12:15], s64 offen offset:128
  buffer_load_dwordx4 v[180:183], v136, s[12:15], s64 offen offset:160
  buffer_load_dwordx4 v[184:187], v136, s[12:15], s64 offen offset:192
  buffer_load_dwordx4 v[188:191], v136, s[12:15], s64 offen offset:224
  s_waitcnt vmcnt(0)
  v_mfma_f32_32x32x16_bf16 v[216:231], v[176:179], v[160:163], v[216:231]
  v_mfma_f32_32x32x16_bf16 v[216:231], v[180:183], v[164:167], v[216:231]
  v_mfma_f32_32x32x16_bf16 v[216:231], v[184:187], v[168:171], v[216:231]
  v_mfma_f32_32x32x16_bf16 v[216:231], v[188:191], v[172:175], v[216:231]
  s_nop 15
  v_max3_f32 v137, v137, v216, v217
  v_max3_f32 v137, v137, v218, v219
  v_max3_f32 v137, v137, v220, v221
  v_max3_f32 v137, v137, v222, v223
  v_max3_f32 v137, v137, v224, v225
  v_max3_f32 v137, v137, v226, v227
  v_max3_f32 v137, v137, v228, v229
  v_max3_f32 v137, v137, v230, v231
  s_add_u32 s65, s65, 1
  s_cmp_lt_u32 s65, 16
  s_cbranch_scc1 L_fb1
  v_mov_b32 v249, v137
  s_nop 1
  v_permlane32_swap_b32 v137, v249
  v_max_f32 v137, v137, v249
  v_sub_f32 v200, 0, v137
  v_sub_f32 v201, 0, v137
  v_sub_f32 v202, 0, v137
  v_sub_f32 v203, 0, v137
  v_sub_f32 v204, 0, v137
  v_sub_f32 v205, 0, v137
  v_sub_f32 v206, 0, v137
  v_sub_f32 v207, 0, v137
  v_sub_f32 v208, 0, v137
  v_sub_f32 v209, 0, v137
  v_sub_f32 v210, 0, v137
  v_sub_f32 v211, 0, v137
  v_sub_f32 v212, 0, v137
  v_sub_f32 v213, 0, v137
  v_sub_f32 v214, 0, v137
  v_sub_f32 v215, 0, v137
  v_mov_b32 v249, 0
  v_mov_b32 v250, 0
  s_mov_b32 s65, 0
L_fb2:
  s_lshl_b32 s64, s65, 13
  s_xor_b32 s64, s64, s66
  buffer_load_dwordx4 v[176:179], v136, s[12:15], s64 offen offset:0
  buffer_load_dwordx4 v[180:183], v136, s[12:15], s64 offen offset:32
  buffer_load_dwordx4 v[184:187], v136, s[12:15], s64 offen offset:64
  buffer_load_dwordx4 v[188:191], v136, s[12:15], s64 offen offset:96
  s_waitcnt vmcnt(0)
  v_mfma_f32_32x32x16_bf16 v[216:231], v[176:179], v[144:147], v[200:215]
  v_mfma_f32_32x32x16_bf16 v[216:231], v[180:183], v[148:151], v[216:231]
  v_mfma_f32_32x32x16_bf16 v[216:231], v[184:187], v[152:155], v[216:231]
  v_mfma_f32_32x32x16_bf16 v[216:231], v[188:191], v[156:159], v[216:231]
  buffer_load_dwordx4 v[176:179], v136, s[12:15], s64 offen offset:128
  buffer_load_dwordx4 v[180:183], v136, s[12:15], s64 offen offset:160
  buffer_load_dwordx4 v[184:187], v136, s[12:15], s64 offen offset:192
  buffer_load_dwordx4 v[188:191], v136, s[12:15], s64 offen offset:224
  s_waitcnt vmcnt(0)
  v_mfma_f32_32x32x16_bf16 v[216:231], v[176:179], v[160:163], v[216:231]
  v_mfma_f32_32x32x16_bf16 v[216:231], v[180:183], v[164:167], v[216:231]
  v_mfma_f32_32x32x16_bf16 v[216:231], v[184:187], v[168:171], v[216:231]
  v_mfma_f32_32x32x16_bf16 v[216:231], v[188:191], v[172:175], v[216:231]
  s_nop 15
  v_exp_f32 v216, v216
  v_exp_f32 v217, v217
  v_exp_f32 v218, v218
  v_exp_f32 v219, v219
  v_add_f32 v249, v249, v216
  v_add_f32 v250, v250, v217
  v_cvt_pk_bf16_f32 v120, v216, v217
  v_exp_f32 v220, v220
  v_exp_f32 v221, v221
  v_add_f32 v249, v249, v218
  v_add_f32 v250, v250, v219
  v_cvt_pk_bf16_f32 v121, v218, v219
  v_exp_f32 v222, v222
  v_exp_f32 v223, v223
  v_add_f32 v249, v249, v220
  v_add_f32 v250, v250, v221
  v_cvt_pk_bf16_f32 v122, v220, v221
  v_exp_f32 v224, v224
  v_exp_f32 v225, v225
  v_add_f32 v249, v249, v222
  v_add_f32 v250, v250, v223
  v_cvt_pk_bf16_f32 v123, v222, v223
  v_exp_f32 v226, v226
  v_exp_f32 v227, v227
  v_add_f32 v249, v249, v224
  v_add_f32 v250, v250, v225
  v_cvt_pk_bf16_f32 v124, v224, v225
  v_exp_f32 v228, v228
  v_exp_f32 v229, v229
  v_add_f32 v249, v249, v226
  v_add_f32 v250, v250, v227
  v_cvt_pk_bf16_f32 v125, v226, v227
  v_exp_f32 v230, v230
  v_exp_f32 v231, v231
  v_add_f32 v249, v249, v228
  v_add_f32 v250, v250, v229
  v_cvt_pk_bf16_f32 v126, v228, v229
  v_add_f32 v249, v249, v230
  v_add_f32 v250, v250, v231
  v_cvt_pk_bf16_f32 v127, v230, v231
  s_lshl_b32 s64, s65, 3
  s_cmp_eq_u32 s65, 15
  s_cselect_b32 s64, 128, s64
  s_set_gpr_idx_on s64, gpr_idx(DST)
  v_mov_b32 v0, v120
  v_mov_b32 v1, v121
  v_mov_b32 v2, v122
  v_mov_b32 v3, v123
  v_mov_b32 v4, v124
  v_mov_b32 v5, v125
  v_mov_b32 v6, v126
  v_mov_b32 v7, v127
  s_set_gpr_idx_off
  s_add_u32 s65, s65, 1
  s_cmp_lt_u32 s65, 16
  s_cbranch_scc1 L_fb2
  v_add_f32 v250, v249, v250
  v_mov_b32 v249, v250
  s_nop 1
  v_permlane32_swap_b32 v250, v249
  v_add_f32 v250, v250, v249
  v_rcp_f32 v250, v250
  ds_read_b64_tr_b16 v[176:177], v248 offset:32768
  ds_read_b64_tr_b16 v[178:179], v248 offset:33280
  s_waitcnt lgkmcnt(0)
  v_mfma_f32_32x32x16_bf16 v[216:231], v[176:179], v[0:3], 0
  ds_read_b64_tr_b16 v[180:181], v248 offset:33792
  ds_read_b64_tr_b16 v[182:183], v248 offset:34304
  s_waitcnt lgkmcnt(0)
  v_mfma_f32_32x32x16_bf16 v[216:231], v[180:183], v[4:7], v[216:231]
  ds_read_b64_tr_b16 v[176:177], v248 offset:34816
  ds_read_b64_tr_b16 v[178:179], v248 offset:35328
  s_waitcnt lgkmcnt(0)
  v_mfma_f32_32x32x16_bf16 v[216:231], v[176:179], v[8:11], v[216:231]
  ds_read_b64_tr_b16 v[180:181], v248 offset:35840
  ds_read_b64_tr_b16 v[182:183], v248 offset:36352
  s_waitcnt lgkmcnt(0)
  v_mfma_f32_32x32x16_bf16 v[216:231], v[180:183], v[12:15], v[216:231]
  ds_read_b64_tr_b16 v[176:177], v248 offset:36864
  ds_read_b64_tr_b16 v[178:179], v248 offset:37376
  s_waitcnt lgkmcnt(0)
  v_mfma_f32_32x32x16_bf16 v[216:231], v[176:179], v[16:19], v[216:231]
  ds_read_b64_tr_b16 v[180:181], v248 offset:37888
  ds_read_b64_tr_b16 v[182:183], v248 offset:38400
  s_waitcnt lgkmcnt(0)
  v_mfma_f32_32x32x16_bf16 v[216:231], v[180:183], v[20:23], v[216:231]
  ds_read_b64_tr_b16 v[176:177], v248 offset:38912
  ds_read_b64_tr_b16 v[178:179], v248 offset:39424
  s_waitcnt lgkmcnt(0)
  v_mfma_f32_32x32x16_bf16 v[216:231], v[176:179], v[24:27], v[216:231]
  ds_read_b64_tr_b16 v[180:181], v248 offset:39936
  ds_read_b64_tr_b16 v[182:183], v248 offset:40448
  s_waitcnt lgkmcnt(0)
  v_mfma_f32_32x32x16_bf16 v[216:231], v[180:183], v[28:31], v[216:231]
  ds_read_b64_tr_b16 v[176:177], v248 offset:40960
  ds_read_b64_tr_b16 v[178:179], v248 offset:41472
  s_waitcnt lgkmcnt(0)
  v_mfma_f32_32x32x16_bf16 v[216:231], v[176:179], v[32:35], v[216:231]
  ds_read_b64_tr_b16 v[180:181], v248 offset:41984
  ds_read_b64_tr_b16 v[182:183], v248 offset:42496
  s_waitcnt lgkmcnt(0)
  v_mfma_f32_32x32x16_bf16 v[216:231], v[180:183], v[36:39], v[216:231]
  ds_read_b64_tr_b16 v[176:177], v248 offset:43008
  ds_read_b64_tr_b16 v[178:179], v248 offset:43520
  s_waitcnt lgkmcnt(0)
  v_mfma_f32_32x32x16_bf16 v[216:231], v[176:179], v[40:43], v[216:231]
  ds_read_b64_tr_b16 v[180:181], v248 offset:44032
  ds_read_b64_tr_b16 v[182:183], v248 offset:44544
  s_waitcnt lgkmcnt(0)
  v_mfma_f32_32x32x16_bf16 v[216:231], v[180:183], v[44:47], v[216:231]
  ds_read_b64_tr_b16 v[176:177], v248 offset:45056
  ds_read_b64_tr_b16 v[178:179], v248 offset:45568
  s_waitcnt lgkmcnt(0)
  v_mfma_f32_32x32x16_bf16 v[216:231], v[176:179], v[48:51], v[216:231]
  ds_read_b64_tr_b16 v[180:181], v248 offset:46080
  ds_read_b64_tr_b16 v[182:183], v248 offset:46592
  s_waitcnt lgkmcnt(0)
  v_mfma_f32_32x32x16_bf16 v[216:231], v[180:183], v[52:55], v[216:231]
  ds_read_b64_tr_b16 v[176:177], v248 offset:47104
  ds_read_b64_tr_b16 v[178:179], v248 offset:47616
  s_waitcnt lgkmcnt(0)
  v_mfma_f32_32x32x16_bf16 v[216:231], v[176:179], v[56:59], v[216:231]
  ds_read_b64_tr_b16 v[180:181], v248 offset:48128
  ds_read_b64_tr_b16 v[182:183], v248 offset:48640
  s_waitcnt lgkmcnt(0)
  v_mfma_f32_32x32x16_bf16 v[216:231], v[180:183], v[60:63], v[216:231]
  ds_read_b64_tr_b16 v[176:177], v248 offset:49152
  ds_read_b64_tr_b16 v[178:179], v248 offset:49664
  s_waitcnt lgkmcnt(0)
  v_mfma_f32_32x32x16_bf16 v[216:231], v[176:179], v[64:67], v[216:231]
  ds_read_b64_tr_b16 v[180:181], v248 offset:50176
  ds_read_b64_tr_b16 v[182:183], v248 offset:50688
  s_waitcnt lgkmcnt(0)
  v_mfma_f32_32x32x16_bf16 v[216:231], v[180:183], v[68:71], v[216:231]
  ds_read_b64_tr_b16 v[176:177], v248 offset:51200
  ds_read_b64_tr_b16 v[178:179], v248 offset:51712
  s_waitcnt lgkmcnt(0)
  v_mfma_f32_32x32x16_bf16 v[216:231], v[176:179], v[72:75], v[216:231]
  ds_read_b64_tr_b16 v[180:181], v248 offset:52224
  ds_read_b64_tr_b16 v[182:183], v248 offset:52736
  s_waitcnt lgkmcnt(0)
  v_mfma_f32_32x32x16_bf16 v[216:231], v[180:183], v[76:79], v[216:231]
  ds_read_b64_tr_b16 v[176:177], v248 offset:53248
  ds_read_b64_tr_b16 v[178:179], v248 offset:53760
  s_waitcnt lgkmcnt(0)
  v_mfma_f32_32x32x16_bf16 v[216:231], v[176:179], v[80:83], v[216:231]
  ds_read_b64_tr_b16 v[180:181], v248 offset:54272
  ds_read_b64_tr_b16 v[182:183], v248 offset:54784
  s_waitcnt lgkmcnt(0)
  v_mfma_f32_32x32x16_bf16 v[216:231], v[180:183], v[84:87], v[216:231]
  ds_read_b64_tr_b16 v[176:177], v248 offset:55296
  ds_read_b64_tr_b16 v[178:179], v248 offset:55808
  s_waitcnt lgkmcnt(0)
  v_mfma_f32_32x32x16_bf16 v[216:231], v[176:179], v[88:91], v[216:231]
  ds_read_b64_tr_b16 v[180:181], v248 offset:56320
  ds_read_b64_tr_b16 v[182:183], v248 offset:56832
  s_waitcnt lgkmcnt(0)
  v_mfma_f32_32x32x16_bf16 v[216:231], v[180:183], v[92:95], v[216:231]
  ds_read_b64_tr_b16 v[176:177], v248 offset:57344
  ds_read_b64_tr_b16 v[178:179], v248 offset:57856
  s_waitcnt lgkmcnt(0)
  v_mfma_f32_32x32x16_bf16 v[216:231], v[176:179], v[96:99], v[216:231]
  ds_read_b64_tr_b16 v[180:181], v248 offset:58368
  ds_read_b64_tr_b16 v[182:183], v248 offset:58880
  s_waitcnt lgkmcnt(0)
  v_mfma_f32_32x32x16_bf16 v[216:231], v[180:183], v[100:103], v[216:231]
  ds_read_b64_tr_b16 v[176:177], v248 offset:59392
  ds_read_b64_tr_b16 v[178:179], v248 offset:59904
  s_waitcnt lgkmcnt(0)
  v_mfma_f32_32x32x16_bf16 v[216:231], v[176:179], v[104:107], v[216:231]
  ds_read_b64_tr_b16 v[180:181], v248 offset:60416
  ds_read_b64_tr_b16 v[182:183], v248 offset:60928
  s_waitcnt lgkmcnt(0)
  v_mfma_f32_32x32x16_bf16 v[216:231], v[180:183], v[108:111], v[216:231]
  ds_read_b64_tr_b16 v[176:177], v248 offset:61440
  ds_read_b64_tr_b16 v[178:179], v248 offset:61952
  s_waitcnt lgkmcnt(0)
  v_mfma_f32_32x32x16_bf16 v[216:231], v[176:179], v[112:115], v[216:231]
  ds_read_b64_tr_b16 v[180:181], v248 offset:62464
  ds_read_b64_tr_b16 v[182:183], v248 offset:62976
  s_waitcnt lgkmcnt(0)
  v_mfma_f32_32x32x16_bf16 v[216:231], v[180:183], v[116:119], v[216:231]
  ds_read_b64_tr_b16 v[176:177], v248 offset:0
  ds_read_b64_tr_b16 v[178:179], v248 offset:512
  s_waitcnt lgkmcnt(0)
  v_mfma_f32_32x32x16_bf16 v[200:215], v[176:179], v[0:3], 0
  ds_read_b64_tr_b16 v[180:181], v248 offset:1024
  ds_read_b64_tr_b16 v[182:183], v248 offset:1536
  s_waitcnt lgkmcnt(0)
  v_mfma_f32_32x32x16_bf16 v[200:215], v[180:183], v[4:7], v[200:215]
  ds_read_b64_tr_b16 v[176:177], v248 offset:2048
  ds_read_b64_tr_b16 v[178:179], v248 offset:2560
  s_waitcnt lgkmcnt(0)
  v_mfma_f32_32x32x16_bf16 v[200:215], v[176:179], v[8:11], v[200:215]
  ds_read_b64_tr_b16 v[180:181], v248 offset:3072
  ds_read_b64_tr_b16 v[182:183], v248 offset:3584
  s_waitcnt lgkmcnt(0)
  v_mfma_f32_32x32x16_bf16 v[200:215], v[180:183], v[12:15], v[200:215]
  ds_read_b64_tr_b16 v[176:177], v248 offset:4096
  ds_read_b64_tr_b16 v[178:179], v248 offset:4608
  s_waitcnt lgkmcnt(0)
  v_mfma_f32_32x32x16_bf16 v[200:215], v[176:179], v[16:19], v[200:215]
  ds_read_b64_tr_b16 v[180:181], v248 offset:5120
  ds_read_b64_tr_b16 v[182:183], v248 offset:5632
  s_waitcnt lgkmcnt(0)
  v_mfma_f32_32x32x16_bf16 v[200:215], v[180:183], v[20:23], v[200:215]
  ds_read_b64_tr_b16 v[176:177], v248 offset:6144
  ds_read_b64_tr_b16 v[178:179], v248 offset:6656
  s_waitcnt lgkmcnt(0)
  v_mfma_f32_32x32x16_bf16 v[200:215], v[176:179], v[24:27], v[200:215]
  ds_read_b64_tr_b16 v[180:181], v248 offset:7168
  ds_read_b64_tr_b16 v[182:183], v248 offset:7680
  s_waitcnt lgkmcnt(0)
  v_mfma_f32_32x32x16_bf16 v[200:215], v[180:183], v[28:31], v[200:215]
  ds_read_b64_tr_b16 v[176:177], v248 offset:8192
  ds_read_b64_tr_b16 v[178:179], v248 offset:8704
  s_waitcnt lgkmcnt(0)
  v_mfma_f32_32x32x16_bf16 v[200:215], v[176:179], v[32:35], v[200:215]
  ds_read_b64_tr_b16 v[180:181], v248 offset:9216
  ds_read_b64_tr_b16 v[182:183], v248 offset:9728
  s_waitcnt lgkmcnt(0)
  v_mfma_f32_32x32x16_bf16 v[200:215], v[180:183], v[36:39], v[200:215]
  s_nop 7
  ds_read_b64_tr_b16 v[192:193], v248 offset:63488
  ds_read_b64_tr_b16 v[194:195], v248 offset:64000
  ds_read_b64_tr_b16 v[196:197], v248 offset:64512
  ds_read_b64_tr_b16 v[198:199], v248 offset:65024
  ds_read_b64_tr_b16 v[176:177], v248 offset:10240
  ds_read_b64_tr_b16 v[178:179], v248 offset:10752
  ds_read_b64_tr_b16 v[180:181], v248 offset:11264
  ds_read_b64_tr_b16 v[182:183], v248 offset:11776
  s_waitcnt lgkmcnt(0)
  s_branch L_join
L_end:
  s_endpgm
.section .rodata,"a"
.p2align 6
.amdhsa_kernel recurrent_scan__sliding_block_cached__moe_arch_mod__prompt_kernel
  .amdhsa_next_free_vgpr 256
  .amdhsa_next_free_sgpr 102
  .amdhsa_accum_offset 256
  .amdhsa_group_segment_fixed_size 0
  .amdhsa_kernarg_size 104
  .amdhsa_user_sgpr_count 2
  .amdhsa_user_sgpr_kernarg_segment_ptr 1
  .amdhsa_system_sgpr_workgroup_id_x 1
.end_amdhsa_kernel
```
